```python
import torch

def _softmax(x, axis=-1):
    return torch.softmax(x, dim=axis)
def _gelu(x):
    return torch.nn.functional.gelu(x, approximate="tanh")
def _silu(x):
    return torch.nn.functional.silu(x)
def _sigmoid(x):
    return torch.sigmoid(x)
def _layernorm(x, axis=-1, eps=1e-5):
    m = x.mean(dim=axis, keepdim=True)
    v = x.var(dim=axis, keepdim=True, unbiased=False)
    return (x - m) / torch.sqrt(v + eps)
def _scatter_add(tgt, idx, src, axis=0):
    return tgt.clone().index_add_(axis, idx, src)
def _segment_sum(src, seg, n):
    out = torch.zeros((n,) + src.shape[1:], dtype=src.dtype)
    return out.index_add_(0, seg, src)
def _pad(x, pw):
    flat = tuple(v for pair in reversed(pw) for v in pair)
    return torch.nn.functional.pad(x, flat)

kernel_name = 'sequential_preLN__linear_attn_block__mixer_channel_mlp__prompt'

def setup_inputs():

    _w = (lambda a: (lambda t: t.to(torch.bfloat16) if t.is_floating_point() else t)(torch.as_tensor(a)))
    def _A_setup():
        B, S, D = 1, 2048, 512
        return {
            "x": _w((lambda *s: torch.randn(*s, dtype=torch.bfloat16) * 0.05)(B, S, D)),
            "wqkv": _w((lambda *s: torch.randn(*s, dtype=torch.bfloat16) * 0.1)(D, 3 * D)),
            "wo": _w((lambda *s: torch.randn(*s, dtype=torch.bfloat16) * 0.05)(D, D)),
        }
    _A_in = _A_setup()

    def _B_setup():
        B, S, D, F = 1, 2048, 512, 1376
        return {
            "x": _w((lambda *s: torch.randn(*s, dtype=torch.bfloat16) * 0.05)(B, S, D)),
            "w1": _w((lambda *s: torch.randn(*s, dtype=torch.bfloat16) * 3.2)(D, F) * (D ** -0.5)),
            "b1": _w((lambda *s: torch.randn(*s, dtype=torch.bfloat16) * 0.8)(F)),
            "w2": _w((lambda *s: torch.randn(*s, dtype=torch.bfloat16) * 0.05)(F, D) * (F ** -0.5)),
            "b2": _w((lambda *s: torch.randn(*s, dtype=torch.bfloat16) * 0.05)(D)),
        }
    _B_in = _B_setup()

    return {
        "A_x": _A_in["x"],
        "A_wqkv": _A_in["wqkv"],
        "A_wo": _A_in["wo"],
        "B_x": _B_in["x"],
        "B_w1": _B_in["w1"],
        "B_b1": _B_in["b1"],
        "B_w2": _B_in["w2"],
        "B_b2": _B_in["b2"],
    }

def reference(A_x, A_wqkv, A_wo, B_x, B_w1, B_b1, B_w2, B_b2):
    def _A_ref(x, wqkv, wo):
        B, S, D = x.shape
        H = 32; Dh = D // H
        qkv = (lambda x, *d: x.permute(*d))((x @ wqkv).reshape(B, S, 3, H, Dh), 2, 0, 3, 1, 4)
        q, k, v = qkv[0], qkv[1], qkv[2]
        phi = lambda t: torch.where(t > 0, t + 1, torch.exp(t)) + 1e-6
        pq, pk = phi(q), phi(k)
        kv = torch.einsum("bhsd,bhse->bhde", pk, v)
        z = torch.einsum("bhsd->bhd", pk)
        num = torch.einsum("bhqd,bhde->bhqe", pq, kv)
        den = torch.einsum("bhqd,bhd->bhq", pq, z)[..., None] + 1e-6
        o = num / den
        return (lambda x, *d: x.permute(*d))(o, 0, 2, 1, 3).reshape(B, S, D) @ wo

    def _B_ref(x, w1, b1, w2, b2):
        y = _layernorm(x, axis=-1)
        h = _gelu(torch.einsum("bsd,df->bsf", y, w1) + b1)
        return torch.einsum("bsf,fd->bsd", h, w2) + b2

    x = A_x
    h = x + _A_ref(_layernorm(x, axis=-1), A_wqkv, A_wo)
    h2 = h + _B_ref(_layernorm(h, axis=-1), B_w1, B_b1, B_w2, B_b2)
    return h2
```

```asm
; @launch grid=(256,1,1) block=(256,1,1) lds=163840
.amdgcn_target "amdgcn-amd-amdhsa--gfx950"
.set CODE_BYTES, L_code_end - sequential_preLN__linear_attn_block__mixer_channel_mlp__prompt_kernel - 128
.text
.p2align 12
.fill 832, 4, 0xbf810000
.globl sequential_preLN__linear_attn_block__mixer_channel_mlp__prompt_kernel
.p2align 8
.type sequential_preLN__linear_attn_block__mixer_channel_mlp__prompt_kernel,@function
sequential_preLN__linear_attn_block__mixer_channel_mlp__prompt_kernel:
    s_cmp_ge_u32 s2, 256
    s_cbranch_scc1 L_end
    s_load_dwordx2 s[28:29], s[0:1], 0
    s_load_dwordx2 s[32:33], s[0:1], 8
    s_load_dwordx16 s[4:19], s[0:1], 16
    s_load_dwordx2 s[52:53], s[0:1], 80
    v_and_b32 v1, 63, v0
    v_lshrrev_b32 v50, 6, v0
    v_mov_b32 v252, 1073741824
    v_readfirstlane_b32 s74, v50
    s_getpc_b64 s[68:69]
    s_lshr_b32 s77, s2, 3
    s_and_b32 s77, s77, 15
    s_lshl_b32 s77, s77, 11
    v_and_b32 v51, 15, v0
    v_lshl_add_u32 v51, v51, 7, s77
    s_mov_b32 s77, CODE_BYTES
    v_min_u32 v51, s77, v51
    v_mov_b32 v71, s69
    v_add_co_u32 v70, vcc, s68, v51
    s_nop 1
    v_addc_co_u32 v71, vcc, 0, v71, vcc
    s_and_b32 s72, s2, 31
    s_lshr_b32 s73, s2, 5
    s_and_b32 s75, s2, 7
    s_lshl_b32 s76, s74, 10
    s_mov_b32 s30, 2097152
    s_mov_b32 s31, 0x20000
    s_mov_b32 s34, 1572864
    s_mov_b32 s35, 0x20000
    s_mov_b32 s54, 18874368
    s_mov_b32 s55, 0x20000
    v_and_b32 v56, 3, v1
    v_lshrrev_b32 v55, 5, v1
    v_bfe_u32 v58, v1, 2, 2
    v_lshl_add_u32 v57, v55, 2, v58
    s_lshl_b32 s77, s74, 3
    v_add_u32 v59, s77, v57
    s_and_b32 s95, s74, 1
    s_lshl_b32 s77, s95, 1
    v_xor_b32 v60, s77, v56
    v_bfe_u32 v61, v1, 4, 1
    v_lshlrev_b32 v62, 6, v61
    v_lshl_add_u32 v60, v60, 4, v62
    s_movk_i32 s77, 3072
    v_mad_u32_u24 v13, v59, s77, v60
    s_add_u32 s80, s75, 0
    s_and_b32 s80, s80, 7
    s_add_u32 s81, s75, 1
    s_and_b32 s81, s81, 7
    s_add_u32 s82, s75, 2
    s_and_b32 s82, s82, 7
    s_add_u32 s83, s75, 3
    s_and_b32 s83, s83, 7
    s_add_u32 s84, s75, 4
    s_and_b32 s84, s84, 7
    s_add_u32 s85, s75, 5
    s_and_b32 s85, s85, 7
    s_add_u32 s86, s75, 6
    s_and_b32 s86, s86, 7
    s_add_u32 s87, s75, 7
    s_and_b32 s87, s87, 7
    s_lshl_b32 s88, s73, 7
    s_add_u32 s89, s88, 98304
    s_lshl_b32 s96, s72, 16
    s_lshl_b32 s3, s72, 19
    s_mul_i32 s77, s72, 4096
    s_add_u32 s3, s3, s77
    s_add_u32 s3, s3, 2097152
    v_lshlrev_b32 v63, 7, v1
    v_cmp_gt_u32 vcc, 16, v1
    s_lshl_b32 s78, s73, 2
    s_add_u32 s78, s78, s74
    v_cndmask_b32 v63, v252, v63, vcc
    s_lshl_b32 s78, s78, 11
    s_add_u32 s78, s78, s96
    v_lshrrev_b32 v65, 1, v1
    v_mul_u32_u24 v65, 3072, v65
    v_and_b32 v66, 1, v1
    v_lshl_add_u32 v65, v66, 10, v65
    v_cmp_gt_u32 vcc, 8, v1
    s_lshr_b32 s97, s2, 3
    s_lshl_b32 s97, s97, 2
    v_cndmask_b32 v65, v252, v65, vcc
    s_add_u32 s97, s97, s74
    s_lshr_b32 s26, s2, 3
    s_and_b32 s27, s26, 7
    s_min_u32 s26, s26, 21
    s_lshl_b32 s26, s26, 7
    s_lshl_b32 s27, s27, 7
    s_mul_i32 s70, s97, 12288
    s_add_u32 s70, s70, 384
    v_lshrrev_b32 v54, 2, v1
    v_mul_u32_u24 v64, 3, v55
    v_xor_b32 v64, v64, v56
    v_lshlrev_b32 v64, 4, v64
    v_lshl_add_u32 v196, v54, 10, v64
    v_add_u32 v197, 15360, v196
    v_add_u32 v198, 30720, v196
    v_add_u32 v199, 46080, v196
    s_lshl_b32 s94, s74, 12
    s_lshl_b32 s77, s75, 1
    s_add_u32 s77, s77, s74
    s_add_u32 s24, s77, 0
    s_and_b32 s24, s24, 15
    s_add_u32 s25, s77, 4
    s_and_b32 s25, s25, 15
    s_add_u32 s98, s77, 8
    s_and_b32 s98, s98, 15
    s_add_u32 s99, s77, 12
    s_and_b32 s99, s99, 15
    s_waitcnt lgkmcnt(0)
    s_add_u32 s77, s52, s3
    s_addc_u32 s79, s53, 0
    v_writelane_b32 v70, s28, 0
    v_writelane_b32 v71, s29, 0
    v_writelane_b32 v70, s32, 1
    v_writelane_b32 v71, s33, 1
    v_writelane_b32 v70, s52, 2
    v_writelane_b32 v71, s53, 2
    v_writelane_b32 v70, s4, 3
    v_writelane_b32 v71, s5, 3
    v_writelane_b32 v70, s8, 4
    v_writelane_b32 v71, s9, 4
    v_writelane_b32 v70, s12, 5
    v_writelane_b32 v71, s13, 5
    v_writelane_b32 v70, s16, 6
    v_writelane_b32 v71, s17, 6
    v_writelane_b32 v70, s18, 7
    v_writelane_b32 v71, s19, 7
    v_writelane_b32 v70, s77, 8
    v_writelane_b32 v71, s79, 8
    s_add_u32 s77, s10, s26
    s_addc_u32 s79, s11, 0
    v_writelane_b32 v70, s77, 9
    v_writelane_b32 v71, s79, 9
    s_add_u32 s77, s14, s27
    s_addc_u32 s79, s15, 0
    v_writelane_b32 v70, s77, 10
    v_writelane_b32 v71, s79, 10
    global_load_dword v254, v[70:71], off
    buffer_load_dword v254, v63, s[28:31], s78 offen
    buffer_load_dword v254, v65, s[32:35], s70 offen offset:1024
    s_lshr_b32 s77, s72, 3
    s_lshl_b32 s77, s77, 2
    s_add_u32 s77, s77, s74
    s_mul_i32 s77, s77, 12288
    s_mul_i32 s78, s75, 196608
    s_add_u32 s77, s77, s78
    s_add_u32 s77, s77, s88
    buffer_load_dword v254, v65, s[32:35], s77 offen offset:1024
    s_add_u32 m0, s94, 0
    s_lshl_b32 s77, s24, 6
    s_add_u32 s77, s77, s96
    buffer_load_dwordx4 v196, s[28:31], s77 offen lds
    buffer_load_dwordx4 v197, s[28:31], s77 offen offset:1024 lds
    buffer_load_dwordx4 v198, s[28:31], s77 offen offset:2048 lds
    buffer_load_dwordx4 v199, s[28:31], s77 offen offset:3072 lds
    s_mov_b32 s36, s4
    s_mov_b32 s37, s5
    s_mov_b32 s38, 524288
    s_mov_b32 s39, 0x20000
    s_mov_b32 s40, s8
    s_mov_b32 s41, s9
    s_mov_b32 s42, 1409024
    s_mov_b32 s43, 0x20000
    s_mov_b32 s44, s12
    s_mov_b32 s45, s13
    s_mov_b32 s46, 1409024
    s_mov_b32 s47, 0x20000
    s_mov_b32 s48, s16
    s_mov_b32 s49, s17
    s_mov_b32 s50, 2097152
    s_mov_b32 s51, 0x20000
    s_mov_b32 s56, s10
    s_mov_b32 s57, s11
    s_mov_b32 s58, 2752
    s_mov_b32 s59, 0x20000
    s_mov_b32 s60, s14
    s_mov_b32 s61, s15
    s_mov_b32 s62, 1024
    s_mov_b32 s63, 0x20000
    s_mov_b32 s64, s18
    s_mov_b32 s65, s19
    s_mov_b32 s66, 256
    s_mov_b32 s67, 0x20000
    v_lshlrev_b32 v17, 4, v1
    s_lshl_b32 s11, s72, 10
    s_add_u32 s11, s11, 589824
    s_mov_b32 s79, 0
    s_mul_i32 s26, s73, 11
    s_and_b32 s77, s73, 1
    s_add_u32 s26, s26, s77
    s_min_u32 s26, s26, 76
    s_cmp_ge_u32 s73, 6
    s_cselect_b32 s77, 1, s77
    s_cmp_eq_u32 s77, 0
    s_cselect_b32 s15, 12, 10
    v_lshrrev_b32 v71, 4, v1
    v_and_b32 v81, 7, v1
    v_lshlrev_b32 v224, 3, v71
    v_lshlrev_b32 v225, 4, v81
    s_mov_b32 s4, 0x358637bd
    s_mov_b32 s5, 0x358637bd
    s_mov_b32 s6, 0x3fb8aa3b
    s_mov_b32 s7, 0x3fb8aa3b
    s_mov_b32 s8, 0xbdd2d3e8
    s_mov_b32 s9, 0xc0135761
    v_mov_b32 v12, 1
    s_mov_b32 s27, 0xffff0000
    s_lshl_b32 s14, s73, 2
    s_add_u32 s14, s14, s74
    s_lshl_b32 s92, s26, 5
    s_add_u32 s93, s92, 88064
    s_lshl_b32 s90, s73, 7
    s_add_u32 s91, s90, 32768
    s_mov_b32 s18, 0xaaaaaaaa
    s_mov_b32 s19, 0xaaaaaaaa
    s_mov_b32 s16, 0x00f0000f
    s_mov_b32 s17, 0xf0000f00
    v_lshl_add_u32 v14, v59, 10, v60
    s_movk_i32 s77, 2752
    v_mad_u32_u24 v15, v59, s77, v60
    s_cmp_eq_u32 s15, 10
    s_cselect_b32 s77, 1073741824, 0
    v_mul_lo_u32 v70, v61, s77
    v_add_u32 v16, v70, v15
    v_lshl_add_u32 v70, v56, 4, v62
    v_lshl_add_u32 v21, v57, 10, v70
    v_and_b32 v72, 15, v1
    v_lshrrev_b32 v73, 3, v72
    v_mul_u32_u24 v73, 3, v73
    v_xor_b32 v74, v73, v71
    v_lshlrev_b32 v74, 4, v74
    v_lshl_add_u32 v74, v72, 6, v74
    s_lshr_b32 s77, s14, 1
    s_lshl_b32 s78, s75, 1
    s_sub_u32 s77, s77, s78
    s_and_b32 s77, s77, 15
    s_lshl_b32 s10, s77, 12
    s_lshl_b32 s78, s95, 1
    v_add_u32 v75, s78, v55
    v_xor_b32 v75, v75, v73
    v_lshlrev_b32 v75, 4, v75
    v_lshl_add_u32 v75, v72, 6, v75
    v_lshl_add_u32 v75, v61, 3, v75
    v_add_u32 v75, s10, v75
    v_lshlrev_b32 v76, 4, v71
    v_lshlrev_b32 v77, 2, v72
    s_xor_b32 s77, s74, 0
    s_lshl_b32 s78, s77, 10
    v_add_u32 v2, s78, v74
    v_add_u32 v6, s78, v17
    v_add_u32 v209, s78, v75
    s_lshl_b32 s77, s77, 6
    s_add_u32 s77, s77, 159744
    v_add_u32 v201, s77, v76
    v_add_u32 v205, s77, v77
    s_xor_b32 s77, s74, 1
    s_lshl_b32 s78, s77, 10
    v_add_u32 v3, s78, v74
    v_add_u32 v7, s78, v17
    v_add_u32 v210, s78, v75
    s_lshl_b32 s77, s77, 6
    s_add_u32 s77, s77, 159744
    v_add_u32 v202, s77, v76
    v_add_u32 v206, s77, v77
    s_xor_b32 s77, s74, 2
    s_lshl_b32 s78, s77, 10
    v_add_u32 v4, s78, v74
    v_add_u32 v8, s78, v17
    v_add_u32 v211, s78, v75
    s_lshl_b32 s77, s77, 6
    s_add_u32 s77, s77, 159744
    v_add_u32 v203, s77, v76
    v_add_u32 v207, s77, v77
    s_xor_b32 s77, s74, 3
    s_lshl_b32 s78, s77, 10
    v_add_u32 v5, s78, v74
    v_add_u32 v9, s78, v17
    v_add_u32 v212, s78, v75
    s_lshl_b32 s77, s77, 6
    s_add_u32 s77, s77, 159744
    v_add_u32 v204, s77, v76
    v_add_u32 v208, s77, v77
    v_mov_b32 v200, v205
    v_xor_b32 v78, s95, v61
    v_lshlrev_b32 v79, 5, v78
    v_lshl_add_u32 v79, v71, 10, v79
    v_lshl_add_u32 v79, v58, 6, v79
    v_lshl_add_u32 v79, v56, 3, v79
    s_lshr_b32 s78, s74, 1
    s_lshl_b32 s78, s78, 8
    s_add_u32 s78, s78, 65536
    v_add_u32 v10, s78, v79
    v_add_u32 v11, 0x10000, v10
    v_mov_b32 v24, 0x3f803f80
    v_mov_b32 v25, 0x3f803f80
    v_mov_b32 v26, 0x3f803f80
    v_mov_b32 v27, 0x3f803f80
    v_xor_b32 v73, s74, v61
    v_lshlrev_b32 v73, 10, v73
    v_lshlrev_b32 v83, 4, v72
    v_lshl_add_u32 v83, v55, 8, v83
    s_lshl_b32 s77, s95, 9
    s_lshr_b32 s78, s14, 1
    s_lshl_b32 s78, s78, 12
    s_add_u32 s77, s77, s78
    s_add_u32 s77, s77, s3
    v_add3_u32 v18, v73, v83, s77
    v_xor_b32 v19, 0x800, v18
    s_lshr_b32 s78, s74, 1
    s_lshl_b32 s78, s78, 12
    v_and_b32 v74, 0xfff, v18
    v_add_u32 v50, s78, v74
    v_xor_b32 v51, 0x800, v50
    s_lshl_b32 s77, s95, 10
    s_add_u32 s101, s77, s78
    v_add_u32 v220, s101, v17
    v_lshlrev_b32 v75, 3, v61
    v_sub_u32 v75, v72, v75
    v_and_b32 v76, 1, v75
    v_lshlrev_b32 v76, 4, v76
    s_movk_i32 s77, 0x3f80
    v_lshlrev_b32_e64 v76, v76, s77
    v_ashrrev_i32 v75, 1, v75
    v_cmp_eq_u32 vcc, 0, v75
    s_nop 1
    v_cndmask_b32 v28, 0, v76, vcc
    v_cmp_eq_u32 vcc, 1, v75
    s_nop 1
    v_cndmask_b32 v29, 0, v76, vcc
    v_cmp_eq_u32 vcc, 2, v75
    s_nop 1
    v_cndmask_b32 v30, 0, v76, vcc
    v_cmp_eq_u32 vcc, 3, v75
    s_nop 1
    v_cndmask_b32 v31, 0, v76, vcc
    v_cmp_eq_u32 vcc, 0, v61
    v_lshlrev_b32 v74, 9, v71
    s_nop 0
    v_cndmask_b32 v213, v252, v83, vcc
    v_cmp_eq_u32 vcc, 0, v72
    v_lshl_add_u32 v216, v72, 4, v74
    s_nop 0
    v_cndmask_b32 v214, v252, v74, vcc
    s_lshl_b32 s77, s73, 2
    v_mov_b32 v74, s77
    v_cmp_eq_u32 vcc, 0, v0
    s_lshl_b32 s78, s74, 5
    s_add_u32 s77, s77, s78
    v_mov_b32 v75, s77
    v_cndmask_b32 v215, v252, v74, vcc
    v_cmp_eq_u32 vcc, 0, v1
    v_lshlrev_b32 v23, 2, v81
    v_and_b32 v74, 31, v1
    v_cndmask_b32 v251, v252, v75, vcc
    v_lshlrev_b32 v250, 2, v74
    s_getreg_b32 s77, hwreg(HW_REG_XCC_ID)
    s_and_b32 s77, s77, 15
    s_add_u32 s10, s77, 1
    s_cmp_eq_u32 s74, 1
    s_cselect_b32 s12, s36, s32
    s_cselect_b32 s13, s37, s33
    s_cmp_eq_u32 s74, 2
    s_cselect_b32 s12, s40, s12
    s_cselect_b32 s13, s41, s13
    s_cmp_eq_u32 s74, 3
    s_cselect_b32 s12, s44, s12
    s_cselect_b32 s13, s45, s13
    s_movk_i32 s77, 5504
    s_cmp_lt_u32 s74, 2
    s_cselect_b32 s77, 2048, s77
    s_cselect_b32 s78, 0, 42
    v_min_u32 v96, s78, v1
    s_cmp_eq_u32 s74, 0
    s_cselect_b32 s77, 6144, s77
    s_cselect_b32 s78, 2048, 0
    v_lshrrev_b32 v97, 3, v96
    v_mul_lo_u32 v97, v97, s78
    v_lshl_add_u32 v96, v96, 7, v97
    s_mul_i32 s77, s2, s77
    s_add_u32 s12, s12, s77
    s_addc_u32 s13, s13, 0
    v_mov_b32 v223, s13
    v_add_co_u32 v222, vcc, s12, v96
    s_nop 1
    v_addc_co_u32 v223, vcc, 0, v223, vcc
    v_mul_u32_u24 v96, 3072, v1
    v_lshlrev_b32 v97, 10, v1
    v_cmp_gt_u32 vcc, 4, v1
    s_lshl_b32 s71, s97, 12
    s_add_u32 s71, s71, 384
    v_cndmask_b32 v221, v252, v96, vcc
    v_cndmask_b32 v219, v252, v97, vcc
    v_cmp_gt_u32 vcc, 11, v1
    s_mul_i32 s27, s97, 11264
    v_mov_b32 v239, s27
    v_cndmask_b32 v238, v252, v97, vcc
    v_add_u32 v238, v238, v239
    s_and_b32 s27, s97, 31
    s_lshl_b32 s27, s27, 9
    v_lshl_add_u32 v239, v56, 7, s27
    s_mov_b32 s27, 0xffff0000
    v_add_u32 v228, 7168, v21
    v_lshlrev_b32 v76, 3, v72
    v_lshl_add_u32 v75, v71, 12, v76
    s_lshl_b32 s77, s74, 7
    s_add_u32 s77, s77, 327680
    v_add_u32 v22, s77, v75
    v_xor_b32 v75, s74, v71
    v_lshl_add_u32 v75, v75, 7, v76
    s_lshl_b32 s77, s74, 3
    s_add_u32 s77, s77, s73
    s_lshl_b32 s77, s77, 9
    s_add_u32 s77, s77, 327680
    v_add_u32 v230, s77, v75
    s_lshl_b32 s77, s74, 5
    v_lshl_add_u32 v231, v81, 2, s77
    s_lshl_b32 s12, s74, 11
    s_lshl_b32 s13, s74, 14
    v_lshlrev_b32 v75, 10, v55
    v_lshl_add_u32 v75, v61, 5, v75
    v_lshl_add_u32 v75, v58, 6, v75
    v_lshl_add_u32 v75, v56, 3, v75
    s_add_u32 s77, s12, 65536
    v_add_u32 v226, s77, v75
    v_add_u32 v227, 0x10000, v226
    v_add_u32 v229, s13, v75
    s_lshr_b32 s77, s74, 1
    s_lshl_b32 s77, s77, 10
    s_lshl_b32 s78, s95, 7
    s_add_u32 s77, s77, s78
    v_bfe_u32 v75, v1, 2, 1
    v_lshlrev_b32 v75, 12, v75
    v_lshl_add_u32 v75, v56, 8, v75
    v_lshrrev_b32 v76, 3, v1
    v_lshl_add_u32 v75, v76, 4, v75
    v_add_u32 v217, s77, v75
    v_and_b32 v74, 31, v1
    v_lshl_add_u32 v74, v74, 8, s13
    v_add_u32 v75, 0, v55
    v_xor_b32 v75, v75, v81
    v_lshl_add_u32 v240, v75, 4, v74
    v_add_u32 v75, 2, v55
    v_xor_b32 v75, v75, v81
    v_lshl_add_u32 v241, v75, 4, v74
    v_add_u32 v75, 4, v55
    v_xor_b32 v75, v75, v81
    v_lshl_add_u32 v242, v75, 4, v74
    v_add_u32 v75, 6, v55
    v_xor_b32 v75, v75, v81
    v_lshl_add_u32 v243, v75, 4, v74
    v_lshlrev_b32 v75, 1, v81
    v_xor_b32 v75, v75, v76
    v_lshlrev_b32 v75, 4, v75
    v_lshl_add_u32 v75, v76, 8, v75
    v_add_u32 v244, s12, v75
    v_xor_b32 v245, 16, v244
    v_add_u32 v246, 0x8000, v244
    v_add_u32 v247, 0x8000, v245
    s_lshl_b32 s78, s74, 13
    s_add_u32 s77, s96, s78
    s_add_u32 s77, s77, s90
    v_lshl_add_u32 v75, v76, 10, v225
    v_add_u32 v248, s77, v75
    v_add_u32 v249, 0x8000, v248
    s_and_b32 s77, s73, 3
    s_cbranch_scc1 L_noinit
    v_add_u32 v84, s76, v17
    v_cmp_gt_u32 vcc, 64, v0
    v_mov_b32 v88, -1
    v_mov_b32 v89, -1
    v_mov_b32 v90, -1
    v_mov_b32 v91, -1
    v_cndmask_b32 v85, v252, v84, vcc
    v_cmp_gt_u32 vcc, 32, v0
    v_mov_b32 v92, 0
    v_mov_b32 v93, 0
    v_mov_b32 v94, 0
    v_mov_b32 v95, 0
    v_cndmask_b32 v86, v252, v84, vcc
    s_lshr_b32 s78, s73, 2
    s_lshl_b32 s77, s72, 1
    s_add_u32 s77, s77, s78
    s_mul_i32 s77, s77, 9216
    s_lshl_b32 s78, s78, 9
    s_add_u32 s78, s78, s11
    buffer_store_dwordx4 v[88:91], v84, s[52:55], s77 offen sc1
    s_add_u32 s77, s77, 4096
    buffer_store_dwordx4 v[88:91], v84, s[52:55], s77 offen sc1
    s_add_u32 s77, s77, 4096
    buffer_store_dwordx4 v[88:91], v85, s[52:55], s77 offen sc1
    s_add_u32 s77, s77, 4096
    buffer_store_dwordx4 v[92:95], v86, s[52:55], s78 offen sc1
L_noinit:
    s_mov_b32 s12, 0xcccccccc
    s_mov_b32 s13, 0xcccccccc
    s_lshl_b32 s22, s14, 14
    s_lshr_b32 s78, s72, 3
    s_lshl_b32 s77, s75, 2
    s_add_u32 s78, s78, s77
    s_lshl_b32 s77, s78, 9
    s_add_u32 s20, s22, s77
    s_lshl_b32 s23, s14, 11
    s_add_u32 s23, s23, 524288
    s_lshl_b32 s77, s78, 4
    s_add_u32 s21, s23, s77
    s_add_u32 m0, s94, 16384
    s_lshl_b32 s77, s25, 6
    s_add_u32 s77, s77, s96
    buffer_load_dwordx4 v196, s[28:31], s77 offen lds
    buffer_load_dwordx4 v197, s[28:31], s77 offen offset:1024 lds
    buffer_load_dwordx4 v198, s[28:31], s77 offen offset:2048 lds
    buffer_load_dwordx4 v199, s[28:31], s77 offen offset:3072 lds
    s_add_u32 m0, s94, 32768
    s_lshl_b32 s77, s98, 6
    s_add_u32 s77, s77, s96
    buffer_load_dwordx4 v196, s[28:31], s77 offen lds
    buffer_load_dwordx4 v197, s[28:31], s77 offen offset:1024 lds
    buffer_load_dwordx4 v198, s[28:31], s77 offen offset:2048 lds
    buffer_load_dwordx4 v199, s[28:31], s77 offen offset:3072 lds
    s_add_u32 m0, s94, 49152
    s_lshl_b32 s77, s99, 6
    s_add_u32 s77, s77, s96
    buffer_load_dwordx4 v196, s[28:31], s77 offen lds
    buffer_load_dwordx4 v197, s[28:31], s77 offen offset:1024 lds
    buffer_load_dwordx4 v198, s[28:31], s77 offen offset:2048 lds
    buffer_load_dwordx4 v199, s[28:31], s77 offen offset:3072 lds
    s_add_u32 m0, s76, 154624
    s_mul_i32 s77, s80, 196608
    s_add_u32 s77, s77, s88
    buffer_load_dwordx4 v13, s[32:35], s77 offen offset:1024 lds
    s_add_u32 m0, s76, 63488
    s_nop 0
    buffer_load_dwordx4 v13, s[32:35], s77 offen offset:2048 lds
    s_add_u32 m0, s76, 68608
    s_mul_i32 s77, s80, 196608
    s_add_u32 s77, s77, s89
    buffer_load_dwordx4 v13, s[32:35], s77 offen offset:1024 lds
    s_add_u32 m0, s76, 71680
    s_nop 0
    buffer_load_dwordx4 v13, s[32:35], s77 offen offset:2048 lds
    s_mov_b64 exec, 0
    s_cmp_lg_u32 s74, 0
    s_cbranch_scc1 L_tq2
    s_call_b64 s[0:1], T1
L_tq2:
    s_cmp_lg_u32 s74, 1
    s_cbranch_scc1 L_tq3
    s_call_b64 s[0:1], T2
L_tq3:
    s_cmp_lg_u32 s74, 2
    s_cbranch_scc1 L_tq4
    s_call_b64 s[0:1], T3
L_tq4:
    s_cmp_lg_u32 s74, 3
    s_cbranch_scc1 L_tq5
    s_call_b64 s[0:1], T4
L_tq5:
    s_cmp_lg_u32 s74, 0
    s_cbranch_scc1 L_tq7
    s_call_b64 s[0:1], T5
L_tq7:
    s_cmp_lg_u32 s74, 1
    s_cbranch_scc1 L_tq8
    s_call_b64 s[0:1], T6
L_tq8:
    s_cmp_lg_u32 s74, 2
    s_cbranch_scc1 L_tq9
    s_call_b64 s[0:1], T7
L_tq9:
    s_branch L_tdone
L_tret:
    s_setpc_b64 s[0:1]
L_tdone:
    s_mov_b64 exec, -1
    s_waitcnt vmcnt(4)
    s_barrier
    s_and_b32 s78, s73, 3
    s_or_b32 s78, s78, s74
    s_cbranch_scc1 L_noarr
    s_mov_b64 exec, 1
    buffer_atomic_add v12, off, s[64:67], 0
    s_mov_b64 exec, -1
L_noarr:
    ds_read_b128 v[148:151], v2 offset:0
    ds_read_b128 v[152:155], v2 offset:4096
    ds_read_b128 v[156:159], v2 offset:8192
    ds_read_b128 v[160:163], v2 offset:12288
    ds_read_b128 v[164:167], v2 offset:16384
    ds_read_b128 v[168:171], v2 offset:20480
    ds_read_b128 v[172:175], v2 offset:24576
    ds_read_b128 v[176:179], v2 offset:28672
    s_waitcnt lgkmcnt(7)
    v_mfma_f32_16x16x32_bf16 v[92:95], v[24:27], v[148:151], 0
    s_add_u32 m0, s76, 76800
    s_mul_i32 s77, s81, 196608
    s_add_u32 s77, s77, s88
    v_mfma_f32_16x16x32_bf16 v[96:99], v[148:151], v[148:151], 0
    buffer_load_dwordx4 v13, s[32:35], s77 offen offset:1024 lds
    s_add_u32 m0, s76, 79872
    s_waitcnt lgkmcnt(6)
    v_mfma_f32_16x16x32_bf16 v[92:95], v[24:27], v[152:155], v[92:95]
    ds_read_b128 v[148:151], v2 offset:32768
    buffer_load_dwordx4 v13, s[32:35], s77 offen offset:2048 lds
    v_mfma_f32_16x16x32_bf16 v[96:99], v[152:155], v[152:155], v[96:99]
    s_add_u32 m0, s76, 84992
    s_mul_i32 s77, s81, 196608
    s_add_u32 s77, s77, s89
    s_waitcnt lgkmcnt(6)
    v_mfma_f32_16x16x32_bf16 v[92:95], v[24:27], v[156:159], v[92:95]
    ds_read_b128 v[152:155], v2 offset:36864
    buffer_load_dwordx4 v13, s[32:35], s77 offen offset:1024 lds
    v_mfma_f32_16x16x32_bf16 v[96:99], v[156:159], v[156:159], v[96:99]
    s_add_u32 m0, s76, 88064
    s_nop 0
    buffer_load_dwordx4 v13, s[32:35], s77 offen offset:2048 lds
    s_add_u32 m0, s76, 93184
    s_waitcnt lgkmcnt(6)
    v_mfma_f32_16x16x32_bf16 v[92:95], v[24:27], v[160:163], v[92:95]
    s_mul_i32 s77, s82, 196608
    ds_read_b128 v[156:159], v2 offset:40960
    s_add_u32 s77, s77, s88
    v_mfma_f32_16x16x32_bf16 v[96:99], v[160:163], v[160:163], v[96:99]
    buffer_load_dwordx4 v13, s[32:35], s77 offen offset:1024 lds
    s_add_u32 m0, s76, 96256
    s_waitcnt lgkmcnt(6)
    v_mfma_f32_16x16x32_bf16 v[92:95], v[24:27], v[164:167], v[92:95]
    ds_read_b128 v[160:163], v2 offset:45056
    buffer_load_dwordx4 v13, s[32:35], s77 offen offset:2048 lds
    v_mfma_f32_16x16x32_bf16 v[96:99], v[164:167], v[164:167], v[96:99]
    s_waitcnt lgkmcnt(6)
    v_mfma_f32_16x16x32_bf16 v[92:95], v[24:27], v[168:171], v[92:95]
    s_add_u32 m0, s76, 101376
    ds_read_b128 v[164:167], v2 offset:49152
    s_mul_i32 s77, s82, 196608
    v_mfma_f32_16x16x32_bf16 v[96:99], v[168:171], v[168:171], v[96:99]
    s_add_u32 s77, s77, s89
    buffer_load_dwordx4 v13, s[32:35], s77 offen offset:1024 lds
    s_add_u32 m0, s76, 104448
    s_waitcnt lgkmcnt(6)
    v_mfma_f32_16x16x32_bf16 v[92:95], v[24:27], v[172:175], v[92:95]
    ds_read_b128 v[168:171], v2 offset:53248
    buffer_load_dwordx4 v13, s[32:35], s77 offen offset:2048 lds
    v_mfma_f32_16x16x32_bf16 v[96:99], v[172:175], v[172:175], v[96:99]
    s_waitcnt lgkmcnt(6)
    v_mfma_f32_16x16x32_bf16 v[92:95], v[24:27], v[176:179], v[92:95]
    ds_read_b128 v[172:175], v2 offset:57344
    v_mfma_f32_16x16x32_bf16 v[96:99], v[176:179], v[176:179], v[96:99]
    s_waitcnt vmcnt(8)
    s_barrier
    s_waitcnt lgkmcnt(6)
    v_mfma_f32_16x16x32_bf16 v[92:95], v[24:27], v[148:151], v[92:95]
    s_add_u32 s77, s26, s74
    ds_read_b128 v[176:179], v2 offset:61440
    s_lshl_b32 s77, s77, 5
    v_mfma_f32_16x16x32_bf16 v[96:99], v[148:151], v[148:151], v[96:99]
    buffer_load_dwordx2 v[40:41], v224, s[56:59], s77 offen offset:0
    buffer_load_dwordx2 v[42:43], v224, s[56:59], s77 offen offset:128
    s_waitcnt lgkmcnt(6)
    v_mfma_f32_16x16x32_bf16 v[92:95], v[24:27], v[152:155], v[92:95]
    ds_read_b64_tr_b16 v[116:117], v11 offset:24576
    buffer_load_dwordx2 v[44:45], v224, s[56:59], s77 offen offset:256
    v_mfma_f32_16x16x32_bf16 v[96:99], v[152:155], v[152:155], v[96:99]
    buffer_load_dwordx4 v[46:49], v225, s[60:63], s88 offen
    s_waitcnt lgkmcnt(6)
    v_mfma_f32_16x16x32_bf16 v[92:95], v[24:27], v[156:159], v[92:95]
    ds_read_b64_tr_b16 v[118:119], v11 offset:25088
    v_mfma_f32_16x16x32_bf16 v[96:99], v[156:159], v[156:159], v[96:99]
    s_waitcnt lgkmcnt(6)
    v_mfma_f32_16x16x32_bf16 v[92:95], v[24:27], v[160:163], v[92:95]
    ds_read_b128 v[100:103], v2 offset:0
    v_mfma_f32_16x16x32_bf16 v[96:99], v[160:163], v[160:163], v[96:99]
    s_waitcnt lgkmcnt(6)
    v_mfma_f32_16x16x32_bf16 v[92:95], v[24:27], v[164:167], v[92:95]
    s_add_u32 m0, s76, 109568
    ds_read_b64_tr_b16 v[120:121], v10 offset:0
    s_mul_i32 s77, s83, 196608
    v_mfma_f32_16x16x32_bf16 v[96:99], v[164:167], v[164:167], v[96:99]
    s_add_u32 s77, s77, s88
    buffer_load_dwordx4 v13, s[32:35], s77 offen offset:1024 lds
    s_add_u32 m0, s76, 112640
    s_waitcnt lgkmcnt(6)
    v_mfma_f32_16x16x32_bf16 v[92:95], v[24:27], v[168:171], v[92:95]
    ds_read_b64_tr_b16 v[122:123], v10 offset:512
    buffer_load_dwordx4 v13, s[32:35], s77 offen offset:2048 lds
    v_mfma_f32_16x16x32_bf16 v[96:99], v[168:171], v[168:171], v[96:99]
    s_add_u32 m0, s76, 117760
    s_mul_i32 s77, s83, 196608
    s_add_u32 s77, s77, s89
    s_waitcnt lgkmcnt(6)
    v_mfma_f32_16x16x32_bf16 v[92:95], v[24:27], v[172:175], v[92:95]
    ds_read_b128 v[104:107], v3 offset:0
    buffer_load_dwordx4 v13, s[32:35], s77 offen offset:1024 lds
    v_mfma_f32_16x16x32_bf16 v[96:99], v[172:175], v[172:175], v[96:99]
    s_add_u32 m0, s76, 120832
    s_nop 0
    buffer_load_dwordx4 v13, s[32:35], s77 offen offset:2048 lds
    s_waitcnt lgkmcnt(6)
    v_mfma_f32_16x16x32_bf16 v[92:95], v[24:27], v[176:179], v[92:95]
    ds_read_b128 v[108:111], v4 offset:0
    v_mfma_f32_16x16x32_bf16 v[96:99], v[176:179], v[176:179], v[96:99]
    ds_read_b128 v[112:115], v5 offset:0
    s_waitcnt lgkmcnt(6)
    v_mfma_f32_16x16x32_bf16 v[84:87], v[24:27], v[116:119], 0
    s_waitcnt lgkmcnt(5)
    ds_read_b64_tr_b16 v[140:141], v10 offset:4096
    s_nop 2
    v_cndmask_b32 v180, v96, v97, s[18:19]
    v_mfma_f32_16x16x32_bf16 v[52:55], v[100:103], v[116:119], 0
    s_waitcnt lgkmcnt(4)
    ds_read_b64_tr_b16 v[142:143], v10 offset:4608
    v_cndmask_b32 v188, v98, v99, s[18:19]
    v_mfma_f32_16x16x32_bf16 v[88:91], v[24:27], v[120:123], 0
    ds_read_b128 v[124:127], v2 offset:4096
    v_cndmask_b32 v180, v180, v188, s[12:13]
    v_mfma_f32_16x16x32_bf16 v[68:71], v[100:103], v[120:123], 0
    s_waitcnt lgkmcnt(5)
    ds_read_b64_tr_b16 v[144:145], v10 offset:8192
    v_mul_f32 v181, 0x3b000000, v92
    v_mfma_f32_16x16x32_bf16 v[56:59], v[104:107], v[116:119], 0
    ds_read_b64_tr_b16 v[146:147], v10 offset:8704
    v_mul_f32 v180, 0x3b000000, v180
    v_mfma_f32_16x16x32_bf16 v[72:75], v[104:107], v[120:123], 0
    s_waitcnt lgkmcnt(6)
    ds_read_b128 v[128:131], v3 offset:4096
    v_mul_f32 v187, v181, v181
    v_mfma_f32_16x16x32_bf16 v[60:63], v[108:111], v[116:119], 0
    ds_read_b128 v[132:135], v4 offset:4096
    v_sub_f32 v182, v180, v187
    v_mfma_f32_16x16x32_bf16 v[76:79], v[108:111], v[120:123], 0
    s_waitcnt lgkmcnt(7)
    ds_read_b128 v[136:139], v5 offset:4096
    v_max_f32 v182, 0, v182
T1:
    s_cbranch_execz L_tret
    v_mfma_f32_16x16x32_bf16 v[64:67], v[112:115], v[116:119], 0
    v_cvt_pk_bf16_f32 v187, v181, v182
    v_and_b32 v184, s27, v187
    v_mfma_f32_16x16x32_bf16 v[80:83], v[112:115], v[120:123], 0
    s_waitcnt lgkmcnt(6)
    v_lshlrev_b32 v183, 16, v187
    v_add_f32 v184, 0x3727c5ac, v184
    s_waitcnt vmcnt(12)
    s_waitcnt lgkmcnt(3)
    s_barrier
    v_mfma_f32_16x16x32_bf16 v[84:87], v[24:27], v[140:143], v[84:87]
    s_add_u32 m0, s76, 72704
    ds_read_b64_tr_b16 v[116:117], v10 offset:12288
    s_mul_i32 s77, s84, 196608
    v_mfma_f32_16x16x32_bf16 v[52:55], v[124:127], v[140:143], v[52:55]
    s_add_u32 s77, s77, s88
    ds_read_b64_tr_b16 v[118:119], v10 offset:12800
    buffer_load_dwordx4 v13, s[32:35], s77 offen offset:1024 lds
    v_mfma_f32_16x16x32_bf16 v[88:91], v[24:27], v[144:147], v[88:91]
    s_add_u32 m0, s76, 124928
    ds_read_b128 v[100:103], v2 offset:8192
    buffer_load_dwordx4 v13, s[32:35], s77 offen offset:2048 lds
    v_mfma_f32_16x16x32_bf16 v[68:71], v[124:127], v[144:147], v[68:71]
    s_waitcnt lgkmcnt(5)
    ds_read_b64_tr_b16 v[120:121], v10 offset:16384
    s_add_u32 m0, s76, 154624
    v_mfma_f32_16x16x32_bf16 v[56:59], v[128:131], v[140:143], v[56:59]
    s_mul_i32 s77, s84, 196608
    ds_read_b64_tr_b16 v[122:123], v10 offset:16896
    s_add_u32 s77, s77, s89
    v_mfma_f32_16x16x32_bf16 v[72:75], v[128:131], v[144:147], v[72:75]
    s_waitcnt lgkmcnt(6)
    ds_read_b128 v[104:107], v3 offset:8192
    buffer_load_dwordx4 v13, s[32:35], s77 offen offset:1024 lds
    v_mfma_f32_16x16x32_bf16 v[60:63], v[132:135], v[140:143], v[60:63]
    s_add_u32 m0, s76, 63488
    ds_read_b128 v[108:111], v4 offset:8192
    buffer_load_dwordx4 v13, s[32:35], s77 offen offset:2048 lds
    v_mfma_f32_16x16x32_bf16 v[76:79], v[132:135], v[144:147], v[76:79]
    s_waitcnt lgkmcnt(7)
    ds_read_b128 v[112:115], v5 offset:8192
    s_add_u32 m0, s76, 68608
    v_mfma_f32_16x16x32_bf16 v[64:67], v[136:139], v[140:143], v[64:67]
    s_mul_i32 s77, s85, 196608
    s_add_u32 s77, s77, s88
    buffer_load_dwordx4 v13, s[32:35], s77 offen offset:1024 lds
    v_mfma_f32_16x16x32_bf16 v[80:83], v[136:139], v[144:147], v[80:83]
    s_waitcnt lgkmcnt(6)
    s_add_u32 m0, s76, 129024
    s_nop 0
    buffer_load_dwordx4 v13, s[32:35], s77 offen offset:2048 lds
    v_mfma_f32_16x16x32_bf16 v[84:87], v[24:27], v[116:119], v[84:87]
    s_waitcnt lgkmcnt(5)
    ds_read_b64_tr_b16 v[140:141], v10 offset:20480
    v_cvt_pk_bf16_f32 v187, v184, v184
    v_mfma_f32_16x16x32_bf16 v[52:55], v[100:103], v[116:119], v[52:55]
    s_waitcnt lgkmcnt(4)
    ds_read_b64_tr_b16 v[142:143], v10 offset:20992
    v_lshlrev_b32 v184, 16, v187
    v_mfma_f32_16x16x32_bf16 v[88:91], v[24:27], v[120:123], v[88:91]
    ds_read_b128 v[124:127], v2 offset:12288
    v_sub_f32 v188, v181, v183
    v_mfma_f32_16x16x32_bf16 v[68:71], v[100:103], v[120:123], v[68:71]
    s_waitcnt lgkmcnt(5)
    ds_read_b64_tr_b16 v[144:145], v10 offset:24576
    s_add_u32 m0, s76, 134144
    v_mfma_f32_16x16x32_bf16 v[56:59], v[104:107], v[116:119], v[56:59]
    s_mul_i32 s77, s85, 196608
    ds_read_b64_tr_b16 v[146:147], v10 offset:25088
    s_add_u32 s77, s77, s89
    v_mfma_f32_16x16x32_bf16 v[72:75], v[104:107], v[120:123], v[72:75]
    s_waitcnt lgkmcnt(6)
    ds_read_b128 v[128:131], v3 offset:12288
    buffer_load_dwordx4 v13, s[32:35], s77 offen offset:1024 lds
    v_mfma_f32_16x16x32_bf16 v[60:63], v[108:111], v[116:119], v[60:63]
    s_add_u32 m0, s76, 137216
    ds_read_b128 v[132:135], v4 offset:12288
    buffer_load_dwordx4 v13, s[32:35], s77 offen offset:2048 lds
    v_mfma_f32_16x16x32_bf16 v[76:79], v[108:111], v[120:123], v[76:79]
    s_waitcnt lgkmcnt(7)
    ds_read_b128 v[136:139], v5 offset:12288
    v_mfma_f32_16x16x32_bf16 v[64:67], v[112:115], v[116:119], v[64:67]
    v_sqrt_f32 v185, v184
    v_mfma_f32_16x16x32_bf16 v[80:83], v[112:115], v[120:123], v[80:83]
    s_waitcnt lgkmcnt(6)
    v_cvt_pk_bf16_f32 v187, v185, v185
    v_lshlrev_b32 v185, 16, v187
    s_waitcnt vmcnt(10)
    s_waitcnt lgkmcnt(3)
    s_barrier
    v_mfma_f32_16x16x32_bf16 v[84:87], v[24:27], v[140:143], v[84:87]
    s_add_u32 m0, s76, 76800
    ds_read_b64_tr_b16 v[116:117], v10 offset:28672
    s_mul_i32 s77, s86, 196608
    v_mfma_f32_16x16x32_bf16 v[52:55], v[124:127], v[140:143], v[52:55]
    s_add_u32 s77, s77, s88
    ds_read_b64_tr_b16 v[118:119], v10 offset:29184
    buffer_load_dwordx4 v13, s[32:35], s77 offen offset:1024 lds
    v_mfma_f32_16x16x32_bf16 v[88:91], v[24:27], v[144:147], v[88:91]
    s_add_u32 m0, s76, 88064
    ds_read_b128 v[100:103], v2 offset:16384
    buffer_load_dwordx4 v13, s[32:35], s77 offen offset:2048 lds
    v_mfma_f32_16x16x32_bf16 v[68:71], v[124:127], v[144:147], v[68:71]
    s_waitcnt lgkmcnt(5)
    ds_read_b64_tr_b16 v[120:121], v10 offset:32768
    s_add_u32 m0, s76, 142336
    v_mfma_f32_16x16x32_bf16 v[56:59], v[128:131], v[140:143], v[56:59]
    s_mul_i32 s77, s86, 196608
    ds_read_b64_tr_b16 v[122:123], v10 offset:33280
    s_add_u32 s77, s77, s89
    v_mfma_f32_16x16x32_bf16 v[72:75], v[128:131], v[144:147], v[72:75]
    s_waitcnt lgkmcnt(6)
    ds_read_b128 v[104:107], v3 offset:16384
    buffer_load_dwordx4 v13, s[32:35], s77 offen offset:1024 lds
    v_mfma_f32_16x16x32_bf16 v[60:63], v[132:135], v[140:143], v[60:63]
    s_add_u32 m0, s76, 79872
    ds_read_b128 v[108:111], v4 offset:16384
    buffer_load_dwordx4 v13, s[32:35], s77 offen offset:2048 lds
    v_mfma_f32_16x16x32_bf16 v[76:79], v[132:135], v[144:147], v[76:79]
    s_waitcnt lgkmcnt(7)
    ds_read_b128 v[112:115], v5 offset:16384
    v_mfma_f32_16x16x32_bf16 v[64:67], v[136:139], v[140:143], v[64:67]
    v_rcp_f32 v189, v185
    v_mfma_f32_16x16x32_bf16 v[80:83], v[136:139], v[144:147], v[80:83]
    s_waitcnt lgkmcnt(6)
    s_nop 0
    v_mul_f32_e64 v190, -v183, v189
    v_mfma_f32_16x16x32_bf16 v[84:87], v[24:27], v[116:119], v[84:87]
    s_waitcnt lgkmcnt(5)
    ds_read_b64_tr_b16 v[140:141], v10 offset:36864
    s_add_u32 m0, s76, 84992
    v_mfma_f32_16x16x32_bf16 v[52:55], v[100:103], v[116:119], v[52:55]
    s_waitcnt lgkmcnt(4)
    ds_read_b64_tr_b16 v[142:143], v10 offset:37376
    s_mul_i32 s77, s87, 196608
    v_mfma_f32_16x16x32_bf16 v[88:91], v[24:27], v[120:123], v[88:91]
    s_add_u32 s77, s77, s88
    ds_read_b128 v[124:127], v2 offset:20480
    buffer_load_dwordx4 v13, s[32:35], s77 offen offset:1024 lds
    v_mfma_f32_16x16x32_bf16 v[68:71], v[100:103], v[120:123], v[68:71]
    s_waitcnt lgkmcnt(5)
    ds_read_b64_tr_b16 v[144:145], v10 offset:40960
    s_add_u32 m0, s76, 145408
    v_mfma_f32_16x16x32_bf16 v[56:59], v[104:107], v[116:119], v[56:59]
    ds_read_b64_tr_b16 v[146:147], v10 offset:41472
    buffer_load_dwordx4 v13, s[32:35], s77 offen offset:2048 lds
    v_mfma_f32_16x16x32_bf16 v[72:75], v[104:107], v[120:123], v[72:75]
    s_waitcnt lgkmcnt(6)
    ds_read_b128 v[128:131], v3 offset:20480
    v_mfma_f32_16x16x32_bf16 v[60:63], v[108:111], v[116:119], v[60:63]
    ds_read_b128 v[132:135], v4 offset:20480
    v_mfma_f32_16x16x32_bf16 v[76:79], v[108:111], v[120:123], v[76:79]
    s_waitcnt lgkmcnt(7)
    ds_read_b128 v[136:139], v5 offset:20480
    v_mfma_f32_16x16x32_bf16 v[64:67], v[112:115], v[116:119], v[64:67]
    s_mov_b64 exec, s[16:17]
    ds_write2_b32 v200, v189, v190 offset0:0 offset1:64
    s_mov_b64 exec, -1
    v_mfma_f32_16x16x32_bf16 v[80:83], v[112:115], v[120:123], v[80:83]
    s_waitcnt lgkmcnt(7)
    v_mfma_f32_16x16x32_bf16 v[84:87], v[24:27], v[140:143], v[84:87]
    s_waitcnt lgkmcnt(6)
    ds_read_b64_tr_b16 v[116:117], v10 offset:45056
    v_mfma_f32_16x16x32_bf16 v[52:55], v[124:127], v[140:143], v[52:55]
    s_waitcnt lgkmcnt(5)
    ds_read_b64_tr_b16 v[118:119], v10 offset:45568
    v_mfma_f32_16x16x32_bf16 v[88:91], v[24:27], v[144:147], v[88:91]
    ds_read_b128 v[100:103], v2 offset:24576
    v_mfma_f32_16x16x32_bf16 v[68:71], v[124:127], v[144:147], v[68:71]
    s_waitcnt lgkmcnt(6)
    ds_read_b64_tr_b16 v[120:121], v10 offset:49152
    v_mfma_f32_16x16x32_bf16 v[56:59], v[128:131], v[140:143], v[56:59]
    ds_read_b64_tr_b16 v[122:123], v10 offset:49664
    v_mfma_f32_16x16x32_bf16 v[72:75], v[128:131], v[144:147], v[72:75]
    s_waitcnt lgkmcnt(7)
    ds_read_b128 v[104:107], v3 offset:24576
    v_mfma_f32_16x16x32_bf16 v[60:63], v[132:135], v[140:143], v[60:63]
    ds_read_b128 v[108:111], v4 offset:24576
    v_mfma_f32_16x16x32_bf16 v[76:79], v[132:135], v[144:147], v[76:79]
    s_waitcnt lgkmcnt(8)
    ds_read_b128 v[112:115], v5 offset:24576
    v_mfma_f32_16x16x32_bf16 v[64:67], v[136:139], v[140:143], v[64:67]
    v_mfma_f32_16x16x32_bf16 v[80:83], v[136:139], v[144:147], v[80:83]
    s_waitcnt lgkmcnt(6)
    s_waitcnt vmcnt(10)
    s_waitcnt vmcnt(9)
    s_waitcnt lgkmcnt(3)
    s_barrier
    v_mfma_f32_16x16x32_bf16 v[84:87], v[24:27], v[116:119], v[84:87]
    s_add_u32 m0, s76, 93184
    ds_read_b64_tr_b16 v[140:141], v10 offset:53248
    s_mul_i32 s77, s87, 196608
    v_mfma_f32_16x16x32_bf16 v[52:55], v[100:103], v[116:119], v[52:55]
    s_add_u32 s77, s77, s89
    ds_read_b64_tr_b16 v[142:143], v10 offset:53760
    buffer_load_dwordx4 v13, s[32:35], s77 offen offset:1024 lds
    v_mfma_f32_16x16x32_bf16 v[88:91], v[24:27], v[120:123], v[88:91]
    s_add_u32 m0, s76, 112640
    ds_read_b128 v[124:127], v2 offset:28672
    buffer_load_dwordx4 v13, s[32:35], s77 offen offset:2048 lds
    v_mfma_f32_16x16x32_bf16 v[68:71], v[100:103], v[120:123], v[68:71]
    s_waitcnt lgkmcnt(5)
    ds_read_b64_tr_b16 v[144:145], v10 offset:57344
    v_mfma_f32_16x16x32_bf16 v[56:59], v[104:107], v[116:119], v[56:59]
    ds_read_b64_tr_b16 v[146:147], v10 offset:57856
    v_mfma_f32_16x16x32_bf16 v[72:75], v[104:107], v[120:123], v[72:75]
    s_waitcnt lgkmcnt(6)
    ds_read_b128 v[128:131], v3 offset:28672
    v_mfma_f32_16x16x32_bf16 v[60:63], v[108:111], v[116:119], v[60:63]
    ds_read_b128 v[132:135], v4 offset:28672
    v_mfma_f32_16x16x32_bf16 v[76:79], v[108:111], v[120:123], v[76:79]
    s_waitcnt lgkmcnt(7)
    ds_read_b128 v[136:139], v5 offset:28672
    s_add_u32 m0, s76, 151552
    v_mfma_f32_16x16x32_bf16 v[64:67], v[112:115], v[116:119], v[64:67]
    s_mul_i32 s77, s80, 196608
    ds_read_b128 v[148:151], v201
    s_add_u32 s77, s77, s88
    v_mfma_f32_16x16x32_bf16 v[80:83], v[112:115], v[120:123], v[80:83]
    s_waitcnt lgkmcnt(7)
    ds_read_b128 v[164:167], v201 offset:256
    buffer_load_dwordx4 v13, s[32:35], s77 offen lds
    v_mfma_f32_16x16x32_bf16 v[84:87], v[24:27], v[140:143], v[84:87]
    s_waitcnt lgkmcnt(7)
    ds_read_b64_tr_b16 v[116:117], v10 offset:8192
    s_add_u32 m0, s76, 98304
    v_mfma_f32_16x16x32_bf16 v[52:55], v[124:127], v[140:143], v[52:55]
    s_waitcnt lgkmcnt(6)
    ds_read_b64_tr_b16 v[118:119], v10 offset:8704
    s_mul_i32 s77, s80, 196608
    v_mfma_f32_16x16x32_bf16 v[88:91], v[24:27], v[144:147], v[88:91]
    s_add_u32 s77, s77, s89
    ds_read_b128 v[100:103], v2 offset:32768
    buffer_load_dwordx4 v13, s[32:35], s77 offen lds
    v_mfma_f32_16x16x32_bf16 v[68:71], v[124:127], v[144:147], v[68:71]
    s_waitcnt lgkmcnt(7)
    ds_read_b64_tr_b16 v[120:121], v10 offset:61440
    v_mfma_f32_16x16x32_bf16 v[56:59], v[128:131], v[140:143], v[56:59]
    s_add_u32 m0, s76, 102400
    ds_read_b64_tr_b16 v[122:123], v10 offset:61952
    s_mul_i32 s77, s81, 196608
    v_mfma_f32_16x16x32_bf16 v[72:75], v[128:131], v[144:147], v[72:75]
    s_waitcnt lgkmcnt(8)
    ds_read_b128 v[104:107], v3 offset:32768
    s_add_u32 s77, s77, s88
    v_mfma_f32_16x16x32_bf16 v[60:63], v[132:135], v[140:143], v[60:63]
    ds_read_b128 v[108:111], v4 offset:32768
    buffer_load_dwordx4 v13, s[32:35], s77 offen lds
    v_mfma_f32_16x16x32_bf16 v[76:79], v[132:135], v[144:147], v[76:79]
    s_waitcnt lgkmcnt(9)
    ds_read_b128 v[112:115], v5 offset:32768
    v_mfma_f32_16x16x32_bf16 v[64:67], v[136:139], v[140:143], v[64:67]
    s_add_u32 m0, s76, 106496
    ds_read2_b32 v[188:189], v205 offset0:0 offset1:64
    s_mul_i32 s77, s81, 196608
    v_mfma_f32_16x16x32_bf16 v[80:83], v[136:139], v[144:147], v[80:83]
    s_waitcnt lgkmcnt(7)
    ds_read_b64 v[32:33], v209
    s_add_u32 s77, s77, s89
    v_mfma_f32_16x16x32_bf16 v[84:87], v[24:27], v[116:119], v[84:87]
    s_waitcnt lgkmcnt(7)
    ds_read_b64_tr_b16 v[140:141], v11 offset:24576
    buffer_load_dwordx4 v13, s[32:35], s77 offen lds
    v_mfma_f32_16x16x32_bf16 v[52:55], v[100:103], v[116:119], v[52:55]
    s_waitcnt lgkmcnt(6)
    ds_read_b64_tr_b16 v[142:143], v11 offset:25088
    buffer_load_dword v218, off, s[64:67], 0 sc1
    v_mfma_f32_16x16x32_bf16 v[88:91], v[24:27], v[120:123], v[88:91]
    ds_read_b128 v[124:127], v2 offset:36864
    v_mfma_f32_16x16x32_bf16 v[68:71], v[100:103], v[120:123], v[68:71]
    s_waitcnt lgkmcnt(7)
    ds_read_b64_tr_b16 v[144:145], v10 offset:0
    v_mfma_f32_16x16x32_bf16 v[56:59], v[104:107], v[116:119], v[56:59]
    ds_read_b64_tr_b16 v[146:147], v10 offset:512
    v_mfma_f32_16x16x32_bf16 v[72:75], v[104:107], v[120:123], v[72:75]
    s_waitcnt lgkmcnt(8)
    ds_read_b128 v[128:131], v3 offset:36864
    s_add_u32 m0, s76, 110592
    v_mfma_f32_16x16x32_bf16 v[60:63], v[108:111], v[116:119], v[60:63]
    s_mul_i32 s77, s82, 196608
    ds_read_b128 v[132:135], v4 offset:36864
    s_add_u32 s77, s77, s88
    v_mfma_f32_16x16x32_bf16 v[76:79], v[108:111], v[120:123], v[76:79]
    s_waitcnt lgkmcnt(9)
    ds_read_b128 v[136:139], v5 offset:36864
    buffer_load_dwordx4 v13, s[32:35], s77 offen lds
    v_mfma_f32_16x16x32_bf16 v[64:67], v[112:115], v[116:119], v[64:67]
    ds_read_b128 v[152:155], v202
    v_mfma_f32_16x16x32_bf16 v[80:83], v[112:115], v[120:123], v[80:83]
    s_waitcnt lgkmcnt(7)
    ds_read_b128 v[168:171], v202 offset:256
    s_waitcnt vmcnt(12)
    s_waitcnt vmcnt(11)
    s_waitcnt lgkmcnt(5)
    s_barrier
    v_mfma_f32_16x16x32_bf16 v[84:87], v[24:27], v[140:143], v[84:87]
    s_add_u32 m0, s76, 65536
    ds_read_b64_tr_b16 v[116:117], v10 offset:4096
    s_mul_i32 s77, s82, 196608
    v_mfma_f32_16x16x32_bf16 v[52:55], v[124:127], v[140:143], v[52:55]
    s_add_u32 s77, s77, s89
    ds_read_b64_tr_b16 v[118:119], v10 offset:4608
    buffer_load_dwordx4 v13, s[32:35], s77 offen lds
    v_mfma_f32_16x16x32_bf16 v[88:91], v[24:27], v[144:147], v[88:91]
    s_add_u32 m0, s76, 73728
    ds_read_b128 v[100:103], v2 offset:40960
    s_mul_i32 s77, s83, 196608
    v_mfma_f32_16x16x32_bf16 v[68:71], v[124:127], v[144:147], v[68:71]
    s_waitcnt lgkmcnt(7)
    ds_read_b64_tr_b16 v[120:121], v11 offset:0
    s_add_u32 s77, s77, s88
    v_mfma_f32_16x16x32_bf16 v[56:59], v[128:131], v[140:143], v[56:59]
    ds_read_b64_tr_b16 v[122:123], v11 offset:512
    buffer_load_dwordx4 v13, s[32:35], s77 offen lds
    v_mfma_f32_16x16x32_bf16 v[72:75], v[128:131], v[144:147], v[72:75]
    s_waitcnt lgkmcnt(8)
    ds_read_b128 v[104:107], v3 offset:40960
    v_mfma_f32_16x16x32_bf16 v[60:63], v[132:135], v[140:143], v[60:63]
    ds_read_b128 v[108:111], v4 offset:40960
    v_mfma_f32_16x16x32_bf16 v[76:79], v[132:135], v[144:147], v[76:79]
    s_waitcnt lgkmcnt(9)
    ds_read_b128 v[112:115], v5 offset:40960
    v_mfma_f32_16x16x32_bf16 v[64:67], v[136:139], v[140:143], v[64:67]
    ds_read2_b32 v[190:191], v206 offset0:0 offset1:64
    v_mfma_f32_16x16x32_bf16 v[80:83], v[136:139], v[144:147], v[80:83]
    s_waitcnt lgkmcnt(7)
    ds_read_b64 v[34:35], v210
    v_mfma_f32_16x16x32_bf16 v[84:87], v[24:27], v[116:119], v[84:87]
    s_waitcnt lgkmcnt(7)
    ds_read_b64_tr_b16 v[140:141], v11 offset:4096
    v_mfma_f32_16x16x32_bf16 v[52:55], v[100:103], v[116:119], v[52:55]
    s_waitcnt lgkmcnt(6)
    ds_read_b64_tr_b16 v[142:143], v11 offset:4608
    v_mfma_f32_16x16x32_bf16 v[88:91], v[24:27], v[120:123], v[88:91]
    ds_read_b128 v[124:127], v2 offset:45056
    v_mfma_f32_16x16x32_bf16 v[68:71], v[100:103], v[120:123], v[68:71]
    s_waitcnt lgkmcnt(7)
    ds_read_b64_tr_b16 v[144:145], v11 offset:8192
    v_mfma_f32_16x16x32_bf16 v[56:59], v[104:107], v[116:119], v[56:59]
    ds_read_b64_tr_b16 v[146:147], v11 offset:8704
    v_mfma_f32_16x16x32_bf16 v[72:75], v[104:107], v[120:123], v[72:75]
    s_waitcnt lgkmcnt(8)
    ds_read_b128 v[128:131], v3 offset:45056
    v_mfma_f32_16x16x32_bf16 v[60:63], v[108:111], v[116:119], v[60:63]
    ds_read_b128 v[132:135], v4 offset:45056
    v_mfma_f32_16x16x32_bf16 v[76:79], v[108:111], v[120:123], v[76:79]
    s_waitcnt lgkmcnt(9)
    ds_read_b128 v[136:139], v5 offset:45056
    s_add_u32 m0, s76, 118784
    v_mfma_f32_16x16x32_bf16 v[64:67], v[112:115], v[116:119], v[64:67]
    s_mul_i32 s77, s83, 196608
    ds_read_b128 v[156:159], v203
    s_add_u32 s77, s77, s89
    v_mfma_f32_16x16x32_bf16 v[80:83], v[112:115], v[120:123], v[80:83]
    s_waitcnt lgkmcnt(7)
    ds_read_b128 v[172:175], v203 offset:256
    buffer_load_dwordx4 v13, s[32:35], s77 offen lds
    v_mfma_f32_16x16x32_bf16 v[84:87], v[24:27], v[140:143], v[84:87]
    s_waitcnt lgkmcnt(7)
    ds_read_b64_tr_b16 v[116:117], v10 offset:12288
    v_mfma_f32_16x16x32_bf16 v[52:55], v[124:127], v[140:143], v[52:55]
    s_waitcnt lgkmcnt(6)
    ds_read_b64_tr_b16 v[118:119], v10 offset:12800
    s_add_u32 m0, s76, 155648
    v_mfma_f32_16x16x32_bf16 v[88:91], v[24:27], v[144:147], v[88:91]
    s_mul_i32 s77, s84, 196608
    ds_read_b128 v[100:103], v2 offset:49152
    s_add_u32 s77, s77, s88
    v_mfma_f32_16x16x32_bf16 v[68:71], v[124:127], v[144:147], v[68:71]
    s_waitcnt lgkmcnt(7)
    ds_read_b64_tr_b16 v[120:121], v10 offset:24576
    buffer_load_dwordx4 v13, s[32:35], s77 offen lds
    v_mfma_f32_16x16x32_bf16 v[56:59], v[128:131], v[140:143], v[56:59]
    s_add_u32 m0, s76, 122880
    ds_read_b64_tr_b16 v[122:123], v10 offset:25088
    s_mul_i32 s77, s84, 196608
    v_mfma_f32_16x16x32_bf16 v[72:75], v[128:131], v[144:147], v[72:75]
    s_waitcnt lgkmcnt(8)
    ds_read_b128 v[104:107], v3 offset:49152
    s_add_u32 s77, s77, s89
    v_mfma_f32_16x16x32_bf16 v[60:63], v[132:135], v[140:143], v[60:63]
    ds_read_b128 v[108:111], v4 offset:49152
    buffer_load_dwordx4 v13, s[32:35], s77 offen lds
    v_mfma_f32_16x16x32_bf16 v[76:79], v[132:135], v[144:147], v[76:79]
    s_waitcnt lgkmcnt(9)
    ds_read_b128 v[112:115], v5 offset:49152
    v_mfma_f32_16x16x32_bf16 v[64:67], v[136:139], v[140:143], v[64:67]
    s_add_u32 m0, s76, 126976
    ds_read2_b32 v[192:193], v207 offset0:0 offset1:64
    s_mul_i32 s77, s85, 196608
    v_mfma_f32_16x16x32_bf16 v[80:83], v[136:139], v[144:147], v[80:83]
    s_waitcnt lgkmcnt(7)
    ds_read_b64 v[36:37], v211
    s_add_u32 s77, s77, s88
    s_waitcnt vmcnt(11)
    s_waitcnt lgkmcnt(5)
    s_barrier
    v_mfma_f32_16x16x32_bf16 v[84:87], v[24:27], v[116:119], v[84:87]
    ds_read_b64_tr_b16 v[140:141], v11 offset:12288
    buffer_load_dwordx4 v13, s[32:35], s77 offen lds
    v_mfma_f32_16x16x32_bf16 v[52:55], v[100:103], v[116:119], v[52:55]
    s_add_u32 m0, s76, 69632
    ds_read_b64_tr_b16 v[142:143], v11 offset:12800
    s_mul_i32 s77, s85, 196608
    v_mfma_f32_16x16x32_bf16 v[88:91], v[24:27], v[120:123], v[88:91]
    s_add_u32 s77, s77, s89
    ds_read_b128 v[124:127], v2 offset:53248
    buffer_load_dwordx4 v13, s[32:35], s77 offen lds
    v_mfma_f32_16x16x32_bf16 v[68:71], v[100:103], v[120:123], v[68:71]
    s_waitcnt lgkmcnt(7)
    ds_read_b64_tr_b16 v[144:145], v10 offset:16384
    s_add_u32 m0, s76, 77824
    v_mfma_f32_16x16x32_bf16 v[56:59], v[104:107], v[116:119], v[56:59]
    s_mul_i32 s77, s86, 196608
    ds_read_b64_tr_b16 v[146:147], v10 offset:16896
    s_add_u32 s77, s77, s88
    v_mfma_f32_16x16x32_bf16 v[72:75], v[104:107], v[120:123], v[72:75]
    s_waitcnt lgkmcnt(8)
    ds_read_b128 v[128:131], v3 offset:53248
    buffer_load_dwordx4 v13, s[32:35], s77 offen lds
    v_mfma_f32_16x16x32_bf16 v[60:63], v[108:111], v[116:119], v[60:63]
    s_add_u32 m0, s76, 90112
    ds_read_b128 v[132:135], v4 offset:53248
    s_mul_i32 s77, s86, 196608
    v_mfma_f32_16x16x32_bf16 v[76:79], v[108:111], v[120:123], v[76:79]
    s_waitcnt lgkmcnt(9)
    ds_read_b128 v[136:139], v5 offset:53248
    s_add_u32 s77, s77, s89
    v_mfma_f32_16x16x32_bf16 v[64:67], v[112:115], v[116:119], v[64:67]
    ds_read_b128 v[160:163], v204
    buffer_load_dwordx4 v13, s[32:35], s77 offen lds
    v_mfma_f32_16x16x32_bf16 v[80:83], v[112:115], v[120:123], v[80:83]
    s_waitcnt lgkmcnt(7)
    s_add_u32 m0, s76, 139264
    s_mul_i32 s77, s87, 196608
    v_mfma_f32_16x16x32_bf16 v[84:87], v[24:27], v[140:143], v[84:87]
    s_waitcnt lgkmcnt(6)
    ds_read_b64_tr_b16 v[116:117], v10 offset:20480
    s_add_u32 s77, s77, s88
    v_mfma_f32_16x16x32_bf16 v[52:55], v[124:127], v[140:143], v[52:55]
    s_waitcnt lgkmcnt(5)
    ds_read_b64_tr_b16 v[118:119], v10 offset:20992
    buffer_load_dwordx4 v13, s[32:35], s77 offen lds
    v_mfma_f32_16x16x32_bf16 v[88:91], v[24:27], v[144:147], v[88:91]
    ds_read_b128 v[100:103], v2 offset:57344
    v_mfma_f32_16x16x32_bf16 v[68:71], v[124:127], v[144:147], v[68:71]
    s_waitcnt lgkmcnt(6)
    ds_read_b64_tr_b16 v[120:121], v11 offset:16384
    v_mfma_f32_16x16x32_bf16 v[56:59], v[128:131], v[140:143], v[56:59]
    ds_read_b64_tr_b16 v[122:123], v11 offset:16896
    v_mfma_f32_16x16x32_bf16 v[72:75], v[128:131], v[144:147], v[72:75]
    s_waitcnt lgkmcnt(7)
    ds_read_b128 v[104:107], v3 offset:57344
    v_mfma_f32_16x16x32_bf16 v[60:63], v[132:135], v[140:143], v[60:63]
    ds_read_b128 v[108:111], v4 offset:57344
    v_mfma_f32_16x16x32_bf16 v[76:79], v[132:135], v[144:147], v[76:79]
    s_waitcnt lgkmcnt(8)
    ds_read_b128 v[112:115], v5 offset:57344
    v_mfma_f32_16x16x32_bf16 v[64:67], v[136:139], v[140:143], v[64:67]
    ds_read_b128 v[176:179], v204 offset:256
    v_mfma_f32_16x16x32_bf16 v[80:83], v[136:139], v[144:147], v[80:83]
    s_waitcnt lgkmcnt(7)
    v_mfma_f32_16x16x32_bf16 v[84:87], v[24:27], v[116:119], v[84:87]
    s_waitcnt lgkmcnt(6)
    ds_read_b64_tr_b16 v[140:141], v10 offset:28672
    v_mfma_f32_16x16x32_bf16 v[52:55], v[100:103], v[116:119], v[52:55]
    s_waitcnt lgkmcnt(5)
    ds_read_b64_tr_b16 v[142:143], v10 offset:29184
    v_mfma_f32_16x16x32_bf16 v[88:91], v[24:27], v[120:123], v[88:91]
    ds_read_b128 v[124:127], v2 offset:61440
    v_mfma_f32_16x16x32_bf16 v[68:71], v[100:103], v[120:123], v[68:71]
    s_waitcnt lgkmcnt(6)
    ds_read_b64_tr_b16 v[144:145], v10 offset:49152
    v_mfma_f32_16x16x32_bf16 v[56:59], v[104:107], v[116:119], v[56:59]
    ds_read_b64_tr_b16 v[146:147], v10 offset:49664
    v_mfma_f32_16x16x32_bf16 v[72:75], v[104:107], v[120:123], v[72:75]
    s_waitcnt lgkmcnt(7)
    ds_read_b128 v[128:131], v3 offset:61440
    v_mfma_f32_16x16x32_bf16 v[60:63], v[108:111], v[116:119], v[60:63]
    ds_read_b128 v[132:135], v4 offset:61440
    v_mfma_f32_16x16x32_bf16 v[76:79], v[108:111], v[120:123], v[76:79]
    s_waitcnt lgkmcnt(8)
    ds_read_b128 v[136:139], v5 offset:61440
    v_mfma_f32_16x16x32_bf16 v[64:67], v[112:115], v[116:119], v[64:67]
    s_add_u32 m0, s76, 131072
    ds_read2_b32 v[194:195], v208 offset0:0 offset1:64
    s_mul_i32 s77, s87, 196608
    v_mfma_f32_16x16x32_bf16 v[80:83], v[112:115], v[120:123], v[80:83]
    s_waitcnt lgkmcnt(7)
    s_add_u32 s77, s77, s89
    buffer_load_dwordx4 v13, s[32:35], s77 offen lds
    s_waitcnt vmcnt(13)
    s_waitcnt lgkmcnt(4)
    s_barrier
    v_mfma_f32_16x16x32_bf16 v[84:87], v[24:27], v[140:143], v[84:87]
    s_sub_u32 s77, s73, s75
    ds_read_b64 v[38:39], v212
    s_and_b32 s77, s77, 7
    v_mfma_f32_16x16x32_bf16 v[52:55], v[124:127], v[140:143], v[52:55]
    s_cmp_gt_u32 s77, 6
    s_cselect_b32 s87, s86, s87
    s_cmp_gt_u32 s77, 5
    s_cselect_b32 s86, s85, s86
    v_mfma_f32_16x16x32_bf16 v[88:91], v[24:27], v[144:147], v[88:91]
    s_cmp_gt_u32 s77, 4
    s_cselect_b32 s85, s84, s85
    s_cmp_gt_u32 s77, 3
    s_cselect_b32 s84, s83, s84
    v_mfma_f32_16x16x32_bf16 v[68:71], v[124:127], v[144:147], v[68:71]
    s_waitcnt lgkmcnt(4)
    s_cmp_gt_u32 s77, 2
    s_cselect_b32 s83, s82, s83
    v_mfma_f32_16x16x32_bf16 v[56:59], v[128:131], v[140:143], v[56:59]
    s_cmp_gt_u32 s77, 1
    s_cselect_b32 s82, s81, s82
    s_cmp_gt_u32 s77, 0
    s_cselect_b32 s81, s80, s81
    v_mfma_f32_16x16x32_bf16 v[72:75], v[128:131], v[144:147], v[72:75]
    s_waitcnt lgkmcnt(3)
    s_mov_b32 s80, s73
    global_load_dword v254, v[222:223], off
    v_mfma_f32_16x16x32_bf16 v[60:63], v[132:135], v[140:143], v[60:63]
    s_add_u32 m0, s76, 94208
    s_mul_i32 s77, s80, 65536
    s_add_u32 s77, s77, s90
    v_mfma_f32_16x16x32_bf16 v[76:79], v[132:135], v[144:147], v[76:79]
    s_waitcnt lgkmcnt(2)
    buffer_load_dwordx4 v14, s[36:39], s77 offen lds
    s_add_u32 m0, s76, 114688
    v_mfma_f32_16x16x32_bf16 v[64:67], v[136:139], v[140:143], v[64:67]
    s_mul_i32 s77, s80, 65536
    s_add_u32 s77, s77, s91
    buffer_load_dwordx4 v14, s[36:39], s77 offen lds
    v_mfma_f32_16x16x32_bf16 v[80:83], v[136:139], v[144:147], v[80:83]
    .p2align 3
    v_pk_fma_f32 v[100:101], v[164:165], v[84:85], s[4:5]
    v_pk_fma_f32 v[102:103], v[166:167], v[84:85], s[4:5]
    v_pk_fma_f32 v[104:105], v[168:169], v[84:85], s[4:5]
    v_pk_fma_f32 v[106:107], v[170:171], v[84:85], s[4:5]
    v_pk_fma_f32 v[108:109], v[172:173], v[84:85], s[4:5]
    v_pk_fma_f32 v[110:111], v[174:175], v[84:85], s[4:5]
    v_pk_fma_f32 v[112:113], v[176:177], v[84:85], s[4:5]
    v_pk_fma_f32 v[114:115], v[178:179], v[84:85], s[4:5]
    v_pk_fma_f32 v[52:53], v[148:149], v[52:53], v[100:101]
    v_pk_fma_f32 v[54:55], v[150:151], v[54:55], v[102:103]
    v_pk_fma_f32 v[56:57], v[152:153], v[56:57], v[104:105]
    v_pk_fma_f32 v[58:59], v[154:155], v[58:59], v[106:107]
    v_pk_fma_f32 v[60:61], v[156:157], v[60:61], v[108:109]
    v_pk_fma_f32 v[62:63], v[158:159], v[62:63], v[110:111]
    v_pk_fma_f32 v[64:65], v[160:161], v[64:65], v[112:113]
    v_pk_fma_f32 v[66:67], v[162:163], v[66:67], v[114:115]
    v_pk_mul_f32 v[164:165], v[164:165], v[88:89]
    v_pk_mul_f32 v[166:167], v[166:167], v[88:89]
    v_pk_mul_f32 v[168:169], v[168:169], v[88:89]
    v_pk_mul_f32 v[170:171], v[170:171], v[88:89]
    v_pk_mul_f32 v[172:173], v[172:173], v[88:89]
    v_pk_mul_f32 v[174:175], v[174:175], v[88:89]
    v_pk_mul_f32 v[176:177], v[176:177], v[88:89]
    v_pk_mul_f32 v[178:179], v[178:179], v[88:89]
    v_pk_fma_f32 v[68:69], v[148:149], v[68:69], v[164:165]
    v_pk_fma_f32 v[70:71], v[150:151], v[70:71], v[166:167]
    v_pk_fma_f32 v[72:73], v[152:153], v[72:73], v[168:169]
    v_pk_fma_f32 v[74:75], v[154:155], v[74:75], v[170:171]
    v_pk_fma_f32 v[76:77], v[156:157], v[76:77], v[172:173]
    v_pk_fma_f32 v[78:79], v[158:159], v[78:79], v[174:175]
    v_pk_fma_f32 v[80:81], v[160:161], v[80:81], v[176:177]
    v_pk_fma_f32 v[82:83], v[162:163], v[82:83], v[178:179]
    v_cvt_pk_bf16_f32 v140, v68, v69
    v_cvt_pk_bf16_f32 v141, v70, v71
    v_cvt_pk_bf16_f32 v142, v72, v73
    v_cvt_pk_bf16_f32 v143, v74, v75
    v_cvt_pk_bf16_f32 v144, v76, v77
    v_cvt_pk_bf16_f32 v145, v78, v79
    v_cvt_pk_bf16_f32 v146, v80, v81
    v_cvt_pk_bf16_f32 v147, v82, v83
    v_pk_mul_f32 v[100:101], v[52:53], s[6:7]
    v_pk_mul_f32 v[102:103], v[54:55], s[6:7]
    v_pk_mul_f32 v[104:105], v[56:57], s[6:7]
    v_pk_mul_f32 v[106:107], v[58:59], s[6:7]
    v_pk_mul_f32 v[108:109], v[60:61], s[6:7]
    v_pk_mul_f32 v[110:111], v[62:63], s[6:7]
    v_pk_mul_f32 v[112:113], v[64:65], s[6:7]
    v_pk_mul_f32 v[114:115], v[66:67], s[6:7]
    v_exp_f32_e64 v100, v100 clamp
    v_exp_f32_e64 v101, v101 clamp
    v_exp_f32_e64 v102, v102 clamp
    v_exp_f32_e64 v103, v103 clamp
    v_exp_f32_e64 v104, v104 clamp
T2:
    s_cbranch_execz L_tret
    v_exp_f32_e64 v105, v105 clamp
    v_exp_f32_e64 v106, v106 clamp
    v_exp_f32_e64 v107, v107 clamp
    v_exp_f32_e64 v108, v108 clamp
    v_exp_f32_e64 v109, v109 clamp
    v_exp_f32_e64 v110, v110 clamp
    v_exp_f32_e64 v111, v111 clamp
    v_exp_f32_e64 v112, v112 clamp
    v_exp_f32_e64 v113, v113 clamp
    v_exp_f32_e64 v114, v114 clamp
    v_exp_f32_e64 v115, v115 clamp
    v_max_f32 v52, s4, v52
    v_max_f32 v53, s4, v53
    v_max_f32 v54, s4, v54
    v_max_f32 v55, s4, v55
    v_max_f32 v56, s4, v56
    v_max_f32 v57, s4, v57
    v_max_f32 v58, s4, v58
    v_max_f32 v59, s4, v59
    v_max_f32 v60, s4, v60
    v_max_f32 v61, s4, v61
    v_max_f32 v62, s4, v62
    v_max_f32 v63, s4, v63
    v_max_f32 v64, s4, v64
    v_max_f32 v65, s4, v65
    v_max_f32 v66, s4, v66
    v_max_f32 v67, s4, v67
    v_pk_add_f32 v[52:53], v[52:53], v[100:101]
    v_pk_add_f32 v[54:55], v[54:55], v[102:103]
    v_pk_add_f32 v[56:57], v[56:57], v[104:105]
    v_pk_add_f32 v[58:59], v[58:59], v[106:107]
    v_pk_add_f32 v[60:61], v[60:61], v[108:109]
    v_pk_add_f32 v[62:63], v[62:63], v[110:111]
    v_pk_add_f32 v[64:65], v[64:65], v[112:113]
    v_pk_add_f32 v[66:67], v[66:67], v[114:115]
    v_cvt_pk_bf16_f32 v132, v52, v53
    v_cvt_pk_bf16_f32 v133, v54, v55
    v_cvt_pk_bf16_f32 v134, v56, v57
    v_cvt_pk_bf16_f32 v135, v58, v59
    v_cvt_pk_bf16_f32 v136, v60, v61
    v_cvt_pk_bf16_f32 v137, v62, v63
    v_cvt_pk_bf16_f32 v138, v64, v65
    v_cvt_pk_bf16_f32 v139, v66, v67
    v_mfma_f32_16x16x32_bf16 v[116:119], v[132:135], v[140:143], 0
    v_mfma_f32_16x16x32_bf16 v[120:123], v[132:135], v[24:27], 0
    v_mfma_f32_16x16x32_bf16 v[116:119], v[136:139], v[144:147], v[116:119]
    v_mfma_f32_16x16x32_bf16 v[120:123], v[136:139], v[24:27], v[120:123]
    s_waitcnt vmcnt(15)
    v_cmp_gt_u32 vcc, 64, v218
    v_mov_b32 v128, s10
    s_cbranch_vccz L_c010_x
L_c010:
    s_sleep 8
    buffer_load_dword v218, off, s[64:67], 0 sc1
    s_waitcnt vmcnt(0)
    v_cmp_gt_u32 vcc, 64, v218
    s_nop 0
    s_cbranch_vccz L_c010_x
    s_add_u32 s79, s79, 1
    s_cmp_lt_u32 s79, 0x200000
    s_cbranch_scc1 L_c010
L_c010_x:
    v_cvt_pk_bf16_f32 v124, v116, v117
    v_cvt_pk_bf16_f32 v125, v118, v119
    v_min_u32 v124, -2, v124
    v_min_u32 v125, -2, v125
    v_mov_b32 v126, v124
    v_mov_b32 v127, v125
    v_min_u32 v120, -2, v120
    v_min_u32 v121, -2, v121
    v_min_u32 v122, -2, v122
    v_min_u32 v123, -2, v123
    v_permlane16_swap_b32 v124, v126
    v_permlane16_swap_b32 v125, v127
    buffer_store_dwordx4 v[124:127], v213, s[52:55], s20 offen sc1
    buffer_store_dwordx4 v[120:123], v214, s[52:55], s21 offen sc1
    buffer_store_dword v128, v215, s[52:55], s11 offen sc1
    s_waitcnt vmcnt(16)
    s_waitcnt vmcnt(7)
    s_barrier
    ds_read_b64_tr_b16 v[88:89], v11 offset:20480
    ds_read_b64_tr_b16 v[90:91], v11 offset:20992
    ds_read_b128 v[68:71], v2 offset:0
    ds_read_b128 v[72:75], v3 offset:0
    ds_read_b128 v[76:79], v4 offset:0
    ds_read_b128 v[80:83], v5 offset:0
    s_waitcnt lgkmcnt(4)
    v_mfma_f32_16x16x32_bf16 v[84:87], v[88:91], v[24:27], 0
    s_waitcnt lgkmcnt(3)
    ds_read_b64_tr_b16 v[96:97], v10 offset:32768
    ds_read_b64_tr_b16 v[98:99], v10 offset:33280
    v_mfma_f32_16x16x32_bf16 v[52:55], v[88:91], v[68:71], 0
    s_waitcnt lgkmcnt(4)
    ds_read_b128 v[176:179], v2 offset:4096
    s_add_u32 m0, s76, 135168
    v_mfma_f32_16x16x32_bf16 v[56:59], v[88:91], v[72:75], 0
    s_waitcnt lgkmcnt(4)
    ds_read_b128 v[180:183], v3 offset:4096
    s_mul_i32 s77, s81, 65536
    v_mfma_f32_16x16x32_bf16 v[60:63], v[88:91], v[76:79], 0
    s_waitcnt lgkmcnt(4)
    ds_read_b128 v[184:187], v4 offset:4096
    s_add_u32 s77, s77, s90
    v_mfma_f32_16x16x32_bf16 v[64:67], v[88:91], v[80:83], 0
    s_waitcnt lgkmcnt(3)
    ds_read_b128 v[92:95], v5 offset:4096
    buffer_load_dwordx4 v14, s[36:39], s77 offen lds
    v_mfma_f32_16x16x32_bf16 v[84:87], v[96:99], v[24:27], v[84:87]
    s_waitcnt lgkmcnt(3)
    ds_read_b64_tr_b16 v[88:89], v10 offset:36864
    ds_read_b64_tr_b16 v[90:91], v10 offset:37376
    v_mfma_f32_16x16x32_bf16 v[52:55], v[96:99], v[176:179], v[52:55]
    s_waitcnt lgkmcnt(4)
    ds_read_b128 v[68:71], v2 offset:8192
    s_add_u32 m0, s76, 143360
    v_mfma_f32_16x16x32_bf16 v[56:59], v[96:99], v[180:183], v[56:59]
    s_waitcnt lgkmcnt(4)
    ds_read_b128 v[72:75], v3 offset:8192
    s_mul_i32 s77, s81, 65536
    v_mfma_f32_16x16x32_bf16 v[60:63], v[96:99], v[184:187], v[60:63]
    s_waitcnt lgkmcnt(4)
    ds_read_b128 v[76:79], v4 offset:8192
    s_add_u32 s77, s77, s91
    v_mfma_f32_16x16x32_bf16 v[64:67], v[96:99], v[92:95], v[64:67]
    s_waitcnt lgkmcnt(3)
    ds_read_b128 v[80:83], v5 offset:8192
    buffer_load_dwordx4 v14, s[36:39], s77 offen lds
    v_mfma_f32_16x16x32_bf16 v[84:87], v[88:91], v[24:27], v[84:87]
    s_waitcnt lgkmcnt(3)
    ds_read_b64_tr_b16 v[96:97], v10 offset:40960
    ds_read_b64_tr_b16 v[98:99], v10 offset:41472
    v_mfma_f32_16x16x32_bf16 v[52:55], v[88:91], v[68:71], v[52:55]
    s_waitcnt lgkmcnt(4)
    ds_read_b128 v[176:179], v2 offset:12288
    s_add_u32 m0, s76, 147456
    v_mfma_f32_16x16x32_bf16 v[56:59], v[88:91], v[72:75], v[56:59]
    s_waitcnt lgkmcnt(4)
    ds_read_b128 v[180:183], v3 offset:12288
    s_mul_i32 s77, s82, 65536
    v_mfma_f32_16x16x32_bf16 v[60:63], v[88:91], v[76:79], v[60:63]
    s_waitcnt lgkmcnt(4)
    ds_read_b128 v[184:187], v4 offset:12288
    s_add_u32 s77, s77, s90
    v_mfma_f32_16x16x32_bf16 v[64:67], v[88:91], v[80:83], v[64:67]
    s_waitcnt lgkmcnt(3)
    ds_read_b128 v[92:95], v5 offset:12288
    buffer_load_dwordx4 v14, s[36:39], s77 offen lds
    v_mfma_f32_16x16x32_bf16 v[84:87], v[96:99], v[24:27], v[84:87]
    s_waitcnt lgkmcnt(3)
    ds_read_b64_tr_b16 v[88:89], v10 offset:45056
    ds_read_b64_tr_b16 v[90:91], v10 offset:45568
    v_mfma_f32_16x16x32_bf16 v[52:55], v[96:99], v[176:179], v[52:55]
    s_waitcnt lgkmcnt(4)
    ds_read_b128 v[68:71], v2 offset:16384
    s_add_u32 m0, s76, 81920
    v_mfma_f32_16x16x32_bf16 v[56:59], v[96:99], v[180:183], v[56:59]
    s_waitcnt lgkmcnt(4)
    ds_read_b128 v[72:75], v3 offset:16384
    s_mul_i32 s77, s82, 65536
    v_mfma_f32_16x16x32_bf16 v[60:63], v[96:99], v[184:187], v[60:63]
    s_waitcnt lgkmcnt(4)
    ds_read_b128 v[76:79], v4 offset:16384
    s_add_u32 s77, s77, s91
    v_mfma_f32_16x16x32_bf16 v[64:67], v[96:99], v[92:95], v[64:67]
    s_waitcnt lgkmcnt(3)
    ds_read_b128 v[80:83], v5 offset:16384
    buffer_load_dwordx4 v14, s[36:39], s77 offen lds
    v_mfma_f32_16x16x32_bf16 v[84:87], v[88:91], v[24:27], v[84:87]
    s_waitcnt lgkmcnt(3)
    ds_read_b64_tr_b16 v[96:97], v10 offset:0
    ds_read_b64_tr_b16 v[98:99], v10 offset:512
    v_mfma_f32_16x16x32_bf16 v[52:55], v[88:91], v[68:71], v[52:55]
    s_waitcnt lgkmcnt(4)
    ds_read_b128 v[176:179], v2 offset:20480
    s_add_u32 m0, s76, 86016
    v_mfma_f32_16x16x32_bf16 v[56:59], v[88:91], v[72:75], v[56:59]
    s_waitcnt lgkmcnt(4)
    ds_read_b128 v[180:183], v3 offset:20480
    s_mul_i32 s77, s83, 65536
    v_mfma_f32_16x16x32_bf16 v[60:63], v[88:91], v[76:79], v[60:63]
    s_waitcnt lgkmcnt(4)
    ds_read_b128 v[184:187], v4 offset:20480
    s_add_u32 s77, s77, s90
    v_mfma_f32_16x16x32_bf16 v[64:67], v[88:91], v[80:83], v[64:67]
    s_waitcnt lgkmcnt(3)
    ds_read_b128 v[92:95], v5 offset:20480
    buffer_load_dwordx4 v14, s[36:39], s77 offen lds
    s_waitcnt vmcnt(11)
    s_barrier
    v_mfma_f32_16x16x32_bf16 v[84:87], v[96:99], v[24:27], v[84:87]
    s_waitcnt lgkmcnt(3)
    ds_read_b64_tr_b16 v[88:89], v10 offset:8192
    ds_read_b64_tr_b16 v[90:91], v10 offset:8704
    v_mfma_f32_16x16x32_bf16 v[52:55], v[96:99], v[176:179], v[52:55]
    s_waitcnt lgkmcnt(4)
    ds_read_b128 v[68:71], v2 offset:24576
    s_add_u32 s24, s3, 131072
    v_mfma_f32_16x16x32_bf16 v[56:59], v[96:99], v[180:183], v[56:59]
    s_waitcnt lgkmcnt(4)
    ds_read_b128 v[72:75], v3 offset:24576
    s_mul_i32 s0, s80, 11
    v_mfma_f32_16x16x32_bf16 v[60:63], v[96:99], v[184:187], v[60:63]
    s_waitcnt lgkmcnt(4)
    ds_read_b128 v[76:79], v4 offset:24576
    s_and_b32 s12, s80, 1
    v_mfma_f32_16x16x32_bf16 v[64:67], v[96:99], v[92:95], v[64:67]
    s_waitcnt lgkmcnt(3)
    ds_read_b128 v[80:83], v5 offset:24576
    s_add_u32 s0, s0, s12
    v_mfma_f32_16x16x32_bf16 v[84:87], v[88:91], v[24:27], v[84:87]
    s_waitcnt lgkmcnt(3)
    ds_read_b64_tr_b16 v[96:97], v10 offset:53248
    ds_read_b64_tr_b16 v[98:99], v10 offset:53760
    v_mfma_f32_16x16x32_bf16 v[52:55], v[88:91], v[68:71], v[52:55]
    s_waitcnt lgkmcnt(4)
    ds_read_b128 v[176:179], v2 offset:28672
    s_min_u32 s0, s0, 76
    v_mfma_f32_16x16x32_bf16 v[56:59], v[88:91], v[72:75], v[56:59]
    s_waitcnt lgkmcnt(4)
    ds_read_b128 v[180:183], v3 offset:28672
    s_add_u32 s0, s0, s74
    v_mfma_f32_16x16x32_bf16 v[60:63], v[88:91], v[76:79], v[60:63]
    s_waitcnt lgkmcnt(4)
    ds_read_b128 v[184:187], v4 offset:28672
    s_mul_i32 s1, s81, 11
    v_mfma_f32_16x16x32_bf16 v[64:67], v[88:91], v[80:83], v[64:67]
    s_waitcnt lgkmcnt(3)
    ds_read_b128 v[92:95], v5 offset:28672
    s_add_u32 m0, s76, 65536
    v_mfma_f32_16x16x32_bf16 v[84:87], v[96:99], v[24:27], v[84:87]
    s_waitcnt lgkmcnt(3)
    ds_read_b64_tr_b16 v[88:89], v11 offset:24576
    ds_read_b64_tr_b16 v[90:91], v11 offset:25088
    v_mfma_f32_16x16x32_bf16 v[52:55], v[96:99], v[176:179], v[52:55]
    s_waitcnt lgkmcnt(4)
    ds_read_b128 v[68:71], v2 offset:32768
    s_mul_i32 s77, s83, 65536
    v_mfma_f32_16x16x32_bf16 v[56:59], v[96:99], v[180:183], v[56:59]
    s_waitcnt lgkmcnt(4)
    ds_read_b128 v[72:75], v3 offset:32768
    s_add_u32 s77, s77, s91
    v_mfma_f32_16x16x32_bf16 v[60:63], v[96:99], v[184:187], v[60:63]
    s_waitcnt lgkmcnt(4)
    ds_read_b128 v[76:79], v4 offset:32768
    buffer_load_dwordx4 v14, s[36:39], s77 offen lds
    v_mfma_f32_16x16x32_bf16 v[64:67], v[96:99], v[92:95], v[64:67]
    s_waitcnt lgkmcnt(3)
    ds_read_b128 v[80:83], v5 offset:32768
    s_add_u32 m0, s76, 151552
    v_mfma_f32_16x16x32_bf16 v[84:87], v[88:91], v[24:27], v[84:87]
    s_waitcnt lgkmcnt(3)
    ds_read_b64_tr_b16 v[96:97], v10 offset:57344
    ds_read_b64_tr_b16 v[98:99], v10 offset:57856
    v_mfma_f32_16x16x32_bf16 v[52:55], v[88:91], v[68:71], v[52:55]
    s_waitcnt lgkmcnt(4)
    ds_read_b128 v[176:179], v2 offset:36864
    s_mul_i32 s77, s84, 65536
    v_mfma_f32_16x16x32_bf16 v[56:59], v[88:91], v[72:75], v[56:59]
    s_waitcnt lgkmcnt(4)
    ds_read_b128 v[180:183], v3 offset:36864
    s_add_u32 s77, s77, s90
    v_mfma_f32_16x16x32_bf16 v[60:63], v[88:91], v[76:79], v[60:63]
    s_waitcnt lgkmcnt(4)
    ds_read_b128 v[184:187], v4 offset:36864
    buffer_load_dwordx4 v14, s[36:39], s77 offen lds
    v_mfma_f32_16x16x32_bf16 v[64:67], v[88:91], v[80:83], v[64:67]
    s_waitcnt lgkmcnt(3)
    ds_read_b128 v[92:95], v5 offset:36864
    s_add_u32 m0, s76, 98304
    v_mfma_f32_16x16x32_bf16 v[84:87], v[96:99], v[24:27], v[84:87]
    s_waitcnt lgkmcnt(3)
    ds_read_b64_tr_b16 v[88:89], v10 offset:61440
    ds_read_b64_tr_b16 v[90:91], v10 offset:61952
    v_mfma_f32_16x16x32_bf16 v[52:55], v[96:99], v[176:179], v[52:55]
    s_waitcnt lgkmcnt(4)
    ds_read_b128 v[68:71], v2 offset:40960
    s_mul_i32 s77, s84, 65536
    v_mfma_f32_16x16x32_bf16 v[56:59], v[96:99], v[180:183], v[56:59]
    s_waitcnt lgkmcnt(4)
    ds_read_b128 v[72:75], v3 offset:40960
    s_add_u32 s77, s77, s91
    v_mfma_f32_16x16x32_bf16 v[60:63], v[96:99], v[184:187], v[60:63]
    s_waitcnt lgkmcnt(4)
    ds_read_b128 v[76:79], v4 offset:40960
    buffer_load_dwordx4 v14, s[36:39], s77 offen lds
    v_mfma_f32_16x16x32_bf16 v[64:67], v[96:99], v[92:95], v[64:67]
    s_waitcnt lgkmcnt(3)
    ds_read_b128 v[80:83], v5 offset:40960
    s_add_u32 m0, s76, 102400
    s_waitcnt vmcnt(6)
    s_barrier
    v_mfma_f32_16x16x32_bf16 v[84:87], v[88:91], v[24:27], v[84:87]
    s_waitcnt lgkmcnt(3)
    ds_read_b64_tr_b16 v[96:97], v10 offset:4096
    ds_read_b64_tr_b16 v[98:99], v10 offset:4608
    v_mfma_f32_16x16x32_bf16 v[52:55], v[88:91], v[68:71], v[52:55]
    s_waitcnt lgkmcnt(4)
    ds_read_b128 v[176:179], v2 offset:45056
    s_mul_i32 s77, s85, 65536
    v_mfma_f32_16x16x32_bf16 v[56:59], v[88:91], v[72:75], v[56:59]
    s_waitcnt lgkmcnt(4)
    ds_read_b128 v[180:183], v3 offset:45056
    s_add_u32 s77, s77, s90
    v_mfma_f32_16x16x32_bf16 v[60:63], v[88:91], v[76:79], v[60:63]
    s_waitcnt lgkmcnt(4)
    ds_read_b128 v[184:187], v4 offset:45056
    buffer_load_dwordx4 v14, s[36:39], s77 offen lds
    v_mfma_f32_16x16x32_bf16 v[64:67], v[88:91], v[80:83], v[64:67]
    s_waitcnt lgkmcnt(3)
    ds_read_b128 v[92:95], v5 offset:45056
    s_add_u32 m0, s76, 106496
    v_mfma_f32_16x16x32_bf16 v[84:87], v[96:99], v[24:27], v[84:87]
    s_waitcnt lgkmcnt(3)
    ds_read_b64_tr_b16 v[88:89], v10 offset:12288
    ds_read_b64_tr_b16 v[90:91], v10 offset:12800
    v_mfma_f32_16x16x32_bf16 v[52:55], v[96:99], v[176:179], v[52:55]
    s_waitcnt lgkmcnt(4)
    ds_read_b128 v[68:71], v2 offset:49152
    s_mul_i32 s77, s85, 65536
    v_mfma_f32_16x16x32_bf16 v[56:59], v[96:99], v[180:183], v[56:59]
    s_waitcnt lgkmcnt(4)
    ds_read_b128 v[72:75], v3 offset:49152
    s_add_u32 s77, s77, s91
    v_mfma_f32_16x16x32_bf16 v[60:63], v[96:99], v[184:187], v[60:63]
    s_waitcnt lgkmcnt(4)
    ds_read_b128 v[76:79], v4 offset:49152
    buffer_load_dwordx4 v14, s[36:39], s77 offen lds
    v_mfma_f32_16x16x32_bf16 v[64:67], v[96:99], v[92:95], v[64:67]
    s_waitcnt lgkmcnt(3)
    ds_read_b128 v[80:83], v5 offset:49152
    s_add_u32 m0, s76, 73728
    v_mfma_f32_16x16x32_bf16 v[84:87], v[88:91], v[24:27], v[84:87]
    s_waitcnt lgkmcnt(3)
    ds_read_b64_tr_b16 v[96:97], v10 offset:24576
    ds_read_b64_tr_b16 v[98:99], v10 offset:25088
    v_mfma_f32_16x16x32_bf16 v[52:55], v[88:91], v[68:71], v[52:55]
    s_waitcnt lgkmcnt(4)
    ds_read_b128 v[176:179], v2 offset:53248
    s_mul_i32 s77, s86, 65536
    v_mfma_f32_16x16x32_bf16 v[56:59], v[88:91], v[72:75], v[56:59]
    s_waitcnt lgkmcnt(4)
    ds_read_b128 v[180:183], v3 offset:53248
    s_add_u32 s77, s77, s90
    v_mfma_f32_16x16x32_bf16 v[60:63], v[88:91], v[76:79], v[60:63]
    s_waitcnt lgkmcnt(4)
    ds_read_b128 v[184:187], v4 offset:53248
    buffer_load_dwordx4 v14, s[36:39], s77 offen lds
    v_mfma_f32_16x16x32_bf16 v[64:67], v[88:91], v[80:83], v[64:67]
    s_waitcnt lgkmcnt(3)
    ds_read_b128 v[92:95], v5 offset:53248
    s_add_u32 m0, s76, 110592
    v_mfma_f32_16x16x32_bf16 v[84:87], v[96:99], v[24:27], v[84:87]
    s_waitcnt lgkmcnt(3)
    ds_read_b64_tr_b16 v[88:89], v11 offset:8192
    ds_read_b64_tr_b16 v[90:91], v11 offset:8704
    v_mfma_f32_16x16x32_bf16 v[52:55], v[96:99], v[176:179], v[52:55]
    s_waitcnt lgkmcnt(4)
    ds_read_b128 v[68:71], v2 offset:57344
    s_mul_i32 s77, s86, 65536
    v_mfma_f32_16x16x32_bf16 v[56:59], v[96:99], v[180:183], v[56:59]
    s_waitcnt lgkmcnt(4)
    ds_read_b128 v[72:75], v3 offset:57344
    s_add_u32 s77, s77, s91
    v_mfma_f32_16x16x32_bf16 v[60:63], v[96:99], v[184:187], v[60:63]
    s_waitcnt lgkmcnt(4)
    ds_read_b128 v[76:79], v4 offset:57344
    buffer_load_dwordx4 v14, s[36:39], s77 offen lds
    v_mfma_f32_16x16x32_bf16 v[64:67], v[96:99], v[92:95], v[64:67]
    s_waitcnt lgkmcnt(3)
    ds_read_b128 v[80:83], v5 offset:57344
    s_add_u32 m0, s76, 118784
    v_mfma_f32_16x16x32_bf16 v[84:87], v[88:91], v[24:27], v[84:87]
    s_waitcnt lgkmcnt(3)
    ds_read_b64_tr_b16 v[96:97], v11 offset:0
    ds_read_b64_tr_b16 v[98:99], v11 offset:512
    v_mfma_f32_16x16x32_bf16 v[52:55], v[88:91], v[68:71], v[52:55]
    s_waitcnt lgkmcnt(4)
    ds_read_b128 v[176:179], v2 offset:61440
    s_mul_i32 s77, s87, 65536
    v_mfma_f32_16x16x32_bf16 v[56:59], v[88:91], v[72:75], v[56:59]
    s_waitcnt lgkmcnt(4)
    ds_read_b128 v[180:183], v3 offset:61440
    s_add_u32 s77, s77, s90
    v_mfma_f32_16x16x32_bf16 v[60:63], v[88:91], v[76:79], v[60:63]
    s_waitcnt lgkmcnt(4)
    ds_read_b128 v[184:187], v4 offset:61440
    buffer_load_dwordx4 v14, s[36:39], s77 offen lds
    v_mfma_f32_16x16x32_bf16 v[64:67], v[88:91], v[80:83], v[64:67]
    s_waitcnt lgkmcnt(3)
    ds_read_b128 v[92:95], v5 offset:61440
    s_add_u32 m0, s76, 155648
    v_mfma_f32_16x16x32_bf16 v[84:87], v[96:99], v[24:27], v[84:87]
    s_waitcnt lgkmcnt(3)
    s_mul_i32 s77, s87, 65536
    s_add_u32 s77, s77, s91
    v_mfma_f32_16x16x32_bf16 v[52:55], v[96:99], v[176:179], v[52:55]
    s_waitcnt lgkmcnt(2)
    buffer_load_dwordx4 v14, s[36:39], s77 offen lds
    s_and_b32 s12, s81, 1
    v_mfma_f32_16x16x32_bf16 v[56:59], v[96:99], v[180:183], v[56:59]
    s_waitcnt lgkmcnt(1)
    s_add_u32 s1, s1, s12
    s_min_u32 s1, s1, 76
    v_mfma_f32_16x16x32_bf16 v[60:63], v[96:99], v[184:187], v[60:63]
    s_waitcnt lgkmcnt(0)
    s_add_u32 s1, s1, s74
    s_mul_i32 s13, s82, 11
    v_mfma_f32_16x16x32_bf16 v[64:67], v[96:99], v[92:95], v[64:67]
    s_and_b32 s12, s82, 1
    s_add_u32 s13, s13, s12
    s_min_u32 s13, s13, 76
    s_add_u32 s13, s13, s74
    s_mul_i32 s25, s83, 11
    s_and_b32 s12, s83, 1
    s_add_u32 s25, s25, s12
    s_min_u32 s25, s25, 76
    s_add_u32 s25, s25, s74
    s_mul_i32 s56, s84, 11
    s_and_b32 s12, s84, 1
    s_add_u32 s56, s56, s12
    s_min_u32 s56, s56, 76
    s_add_u32 s56, s56, s74
    s_mul_i32 s57, s85, 11
    s_and_b32 s12, s85, 1
    s_add_u32 s57, s57, s12
    s_min_u32 s57, s57, 76
    s_add_u32 s57, s57, s74
    s_mul_i32 s58, s86, 11
    s_and_b32 s12, s86, 1
    s_add_u32 s58, s58, s12
    s_min_u32 s58, s58, 76
    s_add_u32 s58, s58, s74
    s_mul_i32 s100, s87, 11
    s_and_b32 s12, s87, 1
    s_add_u32 s100, s100, s12
    s_min_u32 s100, s100, 76
    s_add_u32 s100, s100, s74
    s_cmp_lt_u32 s74, 2
    s_cselect_b32 s78, 0xff, 0x15
    s_add_u32 s61, s0, 8
    s_bitcmp1_b32 s78, s80
    s_cselect_b32 s61, s61, 0x10000
    s_add_u32 s62, s1, 8
    s_bitcmp1_b32 s78, s81
    s_cselect_b32 s62, s62, 0x10000
    s_add_u32 s63, s13, 8
    s_bitcmp1_b32 s78, s82
    s_cselect_b32 s63, s63, 0x10000
    s_add_u32 s68, s25, 8
    s_bitcmp1_b32 s78, s83
    s_cselect_b32 s68, s68, 0x10000
    s_add_u32 s18, s56, 8
    s_bitcmp1_b32 s78, s84
    s_cselect_b32 s18, s18, 0x10000
    s_add_u32 s19, s57, 8
    s_bitcmp1_b32 s78, s85
    s_cselect_b32 s19, s19, 0x10000
    s_add_u32 s20, s58, 8
    s_bitcmp1_b32 s78, s86
    s_cselect_b32 s20, s20, 0x10000
    s_add_u32 s21, s100, 8
    s_bitcmp1_b32 s78, s87
    s_cselect_b32 s21, s21, 0x10000
    s_lshl_b32 s59, s74, 11
    s_lshl_b32 s60, s74, 14
    s_add_u32 s12, s74, s26
    s_lshl_b32 s12, s12, 10
    s_add_u32 s69, s12, s24
    s_add_u32 s70, s69, 88064
    s_add_u32 s12, s74, 8
    s_cmp_lt_u32 s12, s15
    s_cselect_b32 s12, 8, 0x100000
    s_lshl_b32 s12, s12, 10
    s_add_u32 s71, s69, 4096
    s_add_u32 s98, s69, s12
    s_add_u32 s97, s70, 4096
    s_add_u32 s99, s70, s12
    v_pk_fma_f32 v[68:69], v[84:85], v[188:189], s[4:5] op_sel:[0,1,0] op_sel_hi:[1,1,1]
    v_pk_fma_f32 v[70:71], v[86:87], v[188:189], s[4:5] op_sel:[0,1,0] op_sel_hi:[1,1,1]
    v_pk_fma_f32 v[72:73], v[84:85], v[190:191], s[4:5] op_sel:[0,1,0] op_sel_hi:[1,1,1]
    v_pk_fma_f32 v[74:75], v[86:87], v[190:191], s[4:5] op_sel:[0,1,0] op_sel_hi:[1,1,1]
    buffer_load_dwordx4 v[164:167], v216, s[52:55], s23 offen sc1
    v_pk_fma_f32 v[76:77], v[84:85], v[192:193], s[4:5] op_sel:[0,1,0] op_sel_hi:[1,1,1]
    v_pk_fma_f32 v[78:79], v[86:87], v[192:193], s[4:5] op_sel:[0,1,0] op_sel_hi:[1,1,1]
    v_pk_fma_f32 v[80:81], v[84:85], v[194:195], s[4:5] op_sel:[0,1,0] op_sel_hi:[1,1,1]
    v_pk_fma_f32 v[82:83], v[86:87], v[194:195], s[4:5] op_sel:[0,1,0] op_sel_hi:[1,1,1]
    buffer_load_dwordx4 v[168:171], v216, s[52:55], s23 offen offset:256 sc1
    v_pk_fma_f32 v[52:53], v[52:53], v[188:189], v[68:69] op_sel:[0,0,0] op_sel_hi:[1,0,1]
    v_pk_fma_f32 v[54:55], v[54:55], v[188:189], v[70:71] op_sel:[0,0,0] op_sel_hi:[1,0,1]
    v_pk_fma_f32 v[56:57], v[56:57], v[190:191], v[72:73] op_sel:[0,0,0] op_sel_hi:[1,0,1]
    v_pk_fma_f32 v[58:59], v[58:59], v[190:191], v[74:75] op_sel:[0,0,0] op_sel_hi:[1,0,1]
    buffer_load_dword v172, v23, s[52:55], s11 offen sc1
    v_pk_fma_f32 v[60:61], v[60:61], v[192:193], v[76:77] op_sel:[0,0,0] op_sel_hi:[1,0,1]
    v_pk_fma_f32 v[62:63], v[62:63], v[192:193], v[78:79] op_sel:[0,0,0] op_sel_hi:[1,0,1]
    v_pk_fma_f32 v[64:65], v[64:65], v[194:195], v[80:81] op_sel:[0,0,0] op_sel_hi:[1,0,1]
    v_pk_fma_f32 v[66:67], v[66:67], v[194:195], v[82:83] op_sel:[0,0,0] op_sel_hi:[1,0,1]
    buffer_load_dwordx4 v[100:103], v17, s[52:55], s22 offen offset:0 sc1
    v_pk_mul_f32 v[68:69], v[52:53], s[6:7]
    v_pk_mul_f32 v[70:71], v[54:55], s[6:7]
    v_pk_mul_f32 v[72:73], v[56:57], s[6:7]
    v_pk_mul_f32 v[74:75], v[58:59], s[6:7]
    buffer_load_dwordx4 v[104:107], v17, s[52:55], s22 offen offset:1024 sc1
    v_pk_mul_f32 v[76:77], v[60:61], s[6:7]
    v_pk_mul_f32 v[78:79], v[62:63], s[6:7]
    v_pk_mul_f32 v[80:81], v[64:65], s[6:7]
    v_pk_mul_f32 v[82:83], v[66:67], s[6:7]
    buffer_load_dwordx4 v[108:111], v17, s[52:55], s22 offen offset:2048 sc1
    v_exp_f32_e64 v68, v68 clamp
    v_exp_f32_e64 v69, v69 clamp
    v_exp_f32_e64 v70, v70 clamp
    v_exp_f32_e64 v71, v71 clamp
    buffer_load_dwordx4 v[112:115], v17, s[52:55], s22 offen offset:3072 sc1
    v_exp_f32_e64 v72, v72 clamp
    v_exp_f32_e64 v73, v73 clamp
    v_exp_f32_e64 v74, v74 clamp
    v_exp_f32_e64 v75, v75 clamp
    s_add_u32 s77, s22, 4096
    buffer_load_dwordx4 v[116:119], v17, s[52:55], s77 offen offset:0 sc1
    v_exp_f32_e64 v76, v76 clamp
    v_exp_f32_e64 v77, v77 clamp
    v_exp_f32_e64 v78, v78 clamp
    v_exp_f32_e64 v79, v79 clamp
    buffer_load_dwordx4 v[120:123], v17, s[52:55], s77 offen offset:1024 sc1
    v_exp_f32_e64 v80, v80 clamp
    v_exp_f32_e64 v81, v81 clamp
    v_exp_f32_e64 v82, v82 clamp
    v_exp_f32_e64 v83, v83 clamp
    buffer_load_dwordx4 v[124:127], v17, s[52:55], s77 offen offset:2048 sc1
    v_max_f32 v52, s4, v52
    v_max_f32 v53, s4, v53
    v_max_f32 v54, s4, v54
    v_max_f32 v55, s4, v55
    buffer_load_dwordx4 v[128:131], v17, s[52:55], s77 offen offset:3072 sc1
    v_max_f32 v56, s4, v56
    v_max_f32 v57, s4, v57
    v_max_f32 v58, s4, v58
    v_max_f32 v59, s4, v59
    v_max_f32 v60, s4, v60
    v_max_f32 v61, s4, v61
    v_max_f32 v62, s4, v62
    v_max_f32 v63, s4, v63
    v_max_f32 v64, s4, v64
    v_max_f32 v65, s4, v65
    v_max_f32 v66, s4, v66
    v_max_f32 v67, s4, v67
    v_pk_add_f32 v[52:53], v[52:53], v[68:69]
    v_pk_add_f32 v[54:55], v[54:55], v[70:71]
    v_pk_add_f32 v[56:57], v[56:57], v[72:73]
    v_pk_add_f32 v[58:59], v[58:59], v[74:75]
    v_pk_add_f32 v[60:61], v[60:61], v[76:77]
    v_pk_add_f32 v[62:63], v[62:63], v[78:79]
    v_pk_add_f32 v[64:65], v[64:65], v[80:81]
    v_pk_add_f32 v[66:67], v[66:67], v[82:83]
    v_cvt_pk_bf16_f32 v180, v52, v53
    v_cvt_pk_bf16_f32 v181, v54, v55
    v_cvt_pk_bf16_f32 v182, v56, v57
    v_cvt_pk_bf16_f32 v183, v58, v59
    v_cvt_pk_bf16_f32 v184, v60, v61
    v_cvt_pk_bf16_f32 v185, v62, v63
    v_cvt_pk_bf16_f32 v186, v64, v65
    v_cvt_pk_bf16_f32 v187, v66, v67
    s_waitcnt vmcnt(11)
    s_barrier
    s_add_u32 s77, s22, 8192
    buffer_load_dwordx4 v[132:135], v17, s[52:55], s77 offen offset:0 sc1
    buffer_load_dwordx4 v[136:139], v17, s[52:55], s77 offen offset:1024 sc1
    buffer_load_dwordx4 v[140:143], v17, s[52:55], s77 offen offset:2048 sc1
    buffer_load_dwordx4 v[144:147], v17, s[52:55], s77 offen offset:3072 sc1
    s_add_u32 s77, s22, 12288
    buffer_load_dwordx4 v[148:151], v17, s[52:55], s77 offen offset:0 sc1
    buffer_load_dwordx4 v[152:155], v17, s[52:55], s77 offen offset:1024 sc1
    buffer_load_dwordx4 v[156:159], v17, s[52:55], s77 offen offset:2048 sc1
    buffer_load_dwordx4 v[160:163], v17, s[52:55], s77 offen offset:3072 sc1
    ds_read_b64_tr_b16 a[192:193], v10 offset:28672
    ds_read_b64_tr_b16 a[194:195], v10 offset:29184
    ds_read_b64_tr_b16 a[196:197], v10 offset:49152
    ds_read_b64_tr_b16 a[198:199], v10 offset:49664
    ds_read_b64_tr_b16 a[200:201], v11 offset:4096
    ds_read_b64_tr_b16 a[202:203], v11 offset:4608
    ds_read_b64_tr_b16 a[204:205], v11 offset:12288
    ds_read_b64_tr_b16 a[206:207], v11 offset:12800
    ds_read_b64_tr_b16 a[208:209], v11 offset:16384
    ds_read_b64_tr_b16 a[210:211], v11 offset:16896
    ds_read_b64_tr_b16 a[212:213], v10 offset:16384
    ds_read_b64_tr_b16 a[214:215], v10 offset:16896
    ds_read_b64_tr_b16 a[216:217], v10 offset:20480
    ds_read_b64_tr_b16 a[218:219], v10 offset:20992
    ds_read_b64_tr_b16 a[220:221], v10 offset:0
    ds_read_b64_tr_b16 a[222:223], v10 offset:512
    ds_read_b64_tr_b16 a[224:225], v11 offset:20480
    ds_read_b64_tr_b16 a[226:227], v11 offset:20992
    ds_read_b64_tr_b16 a[228:229], v10 offset:32768
    ds_read_b64_tr_b16 a[230:231], v10 offset:33280
    ds_read_b64_tr_b16 a[232:233], v10 offset:36864
    ds_read_b64_tr_b16 a[234:235], v10 offset:37376
    ds_read_b64_tr_b16 a[236:237], v10 offset:40960
    ds_read_b64_tr_b16 a[238:239], v10 offset:41472
    ds_read_b64_tr_b16 a[240:241], v10 offset:8192
    ds_read_b64_tr_b16 a[242:243], v10 offset:8704
    ds_read_b64_tr_b16 a[244:245], v10 offset:45056
    ds_read_b64_tr_b16 a[246:247], v10 offset:45568
    ds_read_b64_tr_b16 a[248:249], v10 offset:53248
    ds_read_b64_tr_b16 a[250:251], v10 offset:53760
    ds_read_b64_tr_b16 a[252:253], v11 offset:24576
    ds_read_b64_tr_b16 a[254:255], v11 offset:25088
L_kv11:
    s_waitcnt vmcnt(17)
    v_add_f32 v60, v164, v168
    v_add_f32 v61, v165, v169
    v_add_f32 v62, v166, v170
    v_add_f32 v63, v167, v171
    v_max3_u32 v175, v164, v165, v166
    s_waitcnt vmcnt(16)
    v_add_u32 v64, -1, v172
    v_max3_u32 v175, v175, v64, v167
    v_max3_u32 v175, v175, v168, v169
    v_max3_u32 v175, v175, v170, v171
    v_add_f32_dpp v60, v60, v60 row_ror:1 row_mask:0xf bank_mask:0xf
    v_add_f32_dpp v61, v61, v61 row_ror:1 row_mask:0xf bank_mask:0xf
    v_add_f32_dpp v62, v62, v62 row_ror:1 row_mask:0xf bank_mask:0xf
    v_add_f32_dpp v63, v63, v63 row_ror:1 row_mask:0xf bank_mask:0xf
    v_add_f32_dpp v60, v60, v60 row_ror:2 row_mask:0xf bank_mask:0xf
    v_add_f32_dpp v61, v61, v61 row_ror:2 row_mask:0xf bank_mask:0xf
    v_add_f32_dpp v62, v62, v62 row_ror:2 row_mask:0xf bank_mask:0xf
    v_add_f32_dpp v63, v63, v63 row_ror:2 row_mask:0xf bank_mask:0xf
    v_add_f32_dpp v60, v60, v60 row_ror:4 row_mask:0xf bank_mask:0xf
T3:
    s_cbranch_execz L_tret
    v_add_f32_dpp v61, v61, v61 row_ror:4 row_mask:0xf bank_mask:0xf
    v_add_f32_dpp v62, v62, v62 row_ror:4 row_mask:0xf bank_mask:0xf
    v_add_f32_dpp v63, v63, v63 row_ror:4 row_mask:0xf bank_mask:0xf
    v_add_f32_dpp v60, v60, v60 row_ror:8 row_mask:0xf bank_mask:0xf
    v_add_f32_dpp v61, v61, v61 row_ror:8 row_mask:0xf bank_mask:0xf
    v_add_f32_dpp v62, v62, v62 row_ror:8 row_mask:0xf bank_mask:0xf
    v_add_f32_dpp v63, v63, v63 row_ror:8 row_mask:0xf bank_mask:0xf
    v_cvt_pk_bf16_f32 v58, v60, v61
    v_cvt_pk_bf16_f32 v59, v62, v63
    s_nop 1
    v_mfma_f32_16x16x16_bf16 v[76:79], v[58:59], v[180:181], 0
    v_mfma_f32_16x16x16_bf16 v[80:83], v[58:59], v[182:183], 0
    v_mfma_f32_16x16x16_bf16 v[84:87], v[58:59], v[184:185], 0
    v_mfma_f32_16x16x16_bf16 v[88:91], v[58:59], v[186:187], 0
    s_waitcnt vmcnt(15)
    v_mfma_f32_16x16x32_bf16 v[52:55], v[28:31], v[100:103], 0
    v_max3_u32 v176, v100, v100, v101
    v_max3_u32 v176, v176, v102, v103
    s_waitcnt vmcnt(14)
    v_mfma_f32_16x16x32_bf16 v[52:55], v[28:31], v[104:107], v[52:55]
    v_max3_u32 v176, v176, v104, v105
    v_max3_u32 v176, v176, v106, v107
    s_waitcnt vmcnt(13)
    v_mfma_f32_16x16x32_bf16 v[52:55], v[28:31], v[108:111], v[52:55]
    v_max3_u32 v176, v176, v108, v109
    v_max3_u32 v176, v176, v110, v111
    s_waitcnt vmcnt(12)
    v_mfma_f32_16x16x32_bf16 v[52:55], v[28:31], v[112:115], v[52:55]
    v_max3_u32 v176, v176, v112, v113
    v_max3_u32 v176, v176, v114, v115
    v_add_f32 v76, s4, v76
    v_add_f32 v80, s4, v80
    v_add_f32 v84, s4, v84
    s_waitcnt vmcnt(11)
    v_mfma_f32_16x16x32_bf16 v[52:55], v[28:31], v[116:119], v[52:55]
    v_max3_u32 v177, v116, v116, v117
    v_max3_u32 v177, v177, v118, v119
    v_add_f32 v88, s4, v88
    v_rcp_f32 v76, v76
    s_waitcnt vmcnt(10)
    v_mfma_f32_16x16x32_bf16 v[52:55], v[28:31], v[120:123], v[52:55]
    v_max3_u32 v177, v177, v120, v121
    v_max3_u32 v177, v177, v122, v123
    v_rcp_f32 v80, v80
    s_waitcnt vmcnt(9)
    v_mfma_f32_16x16x32_bf16 v[52:55], v[28:31], v[124:127], v[52:55]
    v_max3_u32 v177, v177, v124, v125
    v_max3_u32 v177, v177, v126, v127
    v_rcp_f32 v84, v84
    s_waitcnt vmcnt(8)
    v_mfma_f32_16x16x32_bf16 v[52:55], v[28:31], v[128:131], v[52:55]
    v_max3_u32 v177, v177, v128, v129
    v_max3_u32 v177, v177, v130, v131
    v_rcp_f32 v88, v88
    s_waitcnt vmcnt(7)
    v_mfma_f32_16x16x32_bf16 v[52:55], v[28:31], v[132:135], v[52:55]
    v_max3_u32 v178, v132, v132, v133
    v_max3_u32 v178, v178, v134, v135
    s_waitcnt vmcnt(6)
    v_mfma_f32_16x16x32_bf16 v[52:55], v[28:31], v[136:139], v[52:55]
    v_max3_u32 v178, v178, v136, v137
    v_max3_u32 v178, v178, v138, v139
    s_waitcnt vmcnt(5)
    v_mfma_f32_16x16x32_bf16 v[52:55], v[28:31], v[140:143], v[52:55]
    v_max3_u32 v178, v178, v140, v141
    v_max3_u32 v178, v178, v142, v143
    s_waitcnt vmcnt(4)
    v_mfma_f32_16x16x32_bf16 v[52:55], v[28:31], v[144:147], v[52:55]
    v_max3_u32 v178, v178, v144, v145
    v_max3_u32 v178, v178, v146, v147
    s_waitcnt vmcnt(3)
    v_mfma_f32_16x16x32_bf16 v[52:55], v[28:31], v[148:151], v[52:55]
    v_max3_u32 v179, v148, v148, v149
    v_max3_u32 v179, v179, v150, v151
    s_waitcnt vmcnt(2)
    v_mfma_f32_16x16x32_bf16 v[52:55], v[28:31], v[152:155], v[52:55]
    v_max3_u32 v179, v179, v152, v153
    v_max3_u32 v179, v179, v154, v155
    s_waitcnt vmcnt(1)
    v_mfma_f32_16x16x32_bf16 v[52:55], v[28:31], v[156:159], v[52:55]
    v_max3_u32 v179, v179, v156, v157
    v_max3_u32 v179, v179, v158, v159
    s_waitcnt vmcnt(0)
    v_mfma_f32_16x16x32_bf16 v[52:55], v[28:31], v[160:163], v[52:55]
    v_max3_u32 v179, v179, v160, v161
    v_max3_u32 v179, v179, v162, v163
    v_max3_u32 v64, v175, v176, v177
    v_max3_u32 v64, v64, v178, v179
    v_cmp_eq_u32 vcc, -1, v64
    s_nop 0
    s_cbranch_vccz L_kv11_x
    v_cmp_eq_u32 vcc, -1, v175
    s_nop 0
    s_cbranch_vccz L_kv11_0
    buffer_load_dwordx4 v[164:167], v216, s[52:55], s23 offen sc1
    buffer_load_dwordx4 v[168:171], v216, s[52:55], s23 offen offset:256 sc1
    buffer_load_dword v172, v23, s[52:55], s11 offen sc1
L_kv11_0:
    v_cmp_eq_u32 vcc, -1, v176
    s_nop 0
    s_cbranch_vccz L_kv11_1
    buffer_load_dwordx4 v[100:103], v17, s[52:55], s22 offen offset:0 sc1
    buffer_load_dwordx4 v[104:107], v17, s[52:55], s22 offen offset:1024 sc1
    buffer_load_dwordx4 v[108:111], v17, s[52:55], s22 offen offset:2048 sc1
    buffer_load_dwordx4 v[112:115], v17, s[52:55], s22 offen offset:3072 sc1
L_kv11_1:
    v_cmp_eq_u32 vcc, -1, v177
    s_nop 0
    s_cbranch_vccz L_kv11_2
    s_add_u32 s77, s22, 4096
    buffer_load_dwordx4 v[116:119], v17, s[52:55], s77 offen offset:0 sc1
    buffer_load_dwordx4 v[120:123], v17, s[52:55], s77 offen offset:1024 sc1
    buffer_load_dwordx4 v[124:127], v17, s[52:55], s77 offen offset:2048 sc1
    buffer_load_dwordx4 v[128:131], v17, s[52:55], s77 offen offset:3072 sc1
L_kv11_2:
    v_cmp_eq_u32 vcc, -1, v178
    s_nop 0
    s_cbranch_vccz L_kv11_3
    s_add_u32 s77, s22, 8192
    buffer_load_dwordx4 v[132:135], v17, s[52:55], s77 offen offset:0 sc1
    buffer_load_dwordx4 v[136:139], v17, s[52:55], s77 offen offset:1024 sc1
    buffer_load_dwordx4 v[140:143], v17, s[52:55], s77 offen offset:2048 sc1
    buffer_load_dwordx4 v[144:147], v17, s[52:55], s77 offen offset:3072 sc1
L_kv11_3:
    v_cmp_eq_u32 vcc, -1, v179
    s_nop 0
    s_cbranch_vccz L_kv11_4
    s_add_u32 s77, s22, 12288
    buffer_load_dwordx4 v[148:151], v17, s[52:55], s77 offen offset:0 sc1
    buffer_load_dwordx4 v[152:155], v17, s[52:55], s77 offen offset:1024 sc1
    buffer_load_dwordx4 v[156:159], v17, s[52:55], s77 offen offset:2048 sc1
    buffer_load_dwordx4 v[160:163], v17, s[52:55], s77 offen offset:3072 sc1
L_kv11_4:
    s_waitcnt vmcnt(0) lgkmcnt(0)
    s_mov_b64 vcc, -1
    s_cbranch_vccz L_kv11_x
    s_add_u32 s79, s79, 1
    s_cmp_lt_u32 s79, 0x200000
    s_cbranch_scc1 L_kv11
L_kv11_x:
    s_nop 1
    v_cvt_pk_bf16_f32 v56, v52, v53
    v_cvt_pk_bf16_f32 v57, v54, v55
    v_cmp_ne_u32 vcc, s10, v172
    s_nop 0
    v_mfma_f32_16x16x16_bf16 v[60:63], v[56:57], v[180:181], 0
    v_mfma_f32_16x16x16_bf16 v[64:67], v[56:57], v[182:183], 0
    v_mfma_f32_16x16x16_bf16 v[68:71], v[56:57], v[184:185], 0
    v_mfma_f32_16x16x16_bf16 v[72:75], v[56:57], v[186:187], 0
    s_cmp_eq_u64 vcc, 0
    s_cselect_b32 s10, 1, 0
    .p2align 3
    s_nop 2
    v_pk_mul_f32 v[60:61], v[60:61], v[76:77] op_sel_hi:[1,0]
    v_pk_mul_f32 v[62:63], v[62:63], v[76:77] op_sel_hi:[1,0]
    v_pk_mul_f32 v[64:65], v[64:65], v[80:81] op_sel_hi:[1,0]
    v_pk_mul_f32 v[66:67], v[66:67], v[80:81] op_sel_hi:[1,0]
    v_pk_mul_f32 v[68:69], v[68:69], v[84:85] op_sel_hi:[1,0]
    v_pk_mul_f32 v[70:71], v[70:71], v[84:85] op_sel_hi:[1,0]
    v_pk_mul_f32 v[72:73], v[72:73], v[88:89] op_sel_hi:[1,0]
    v_pk_mul_f32 v[74:75], v[74:75], v[88:89] op_sel_hi:[1,0]
    v_cvt_pk_bf16_f32 v92, v60, v61
    v_cvt_pk_bf16_f32 v93, v62, v63
    v_cvt_pk_bf16_f32 v94, v64, v65
    v_cvt_pk_bf16_f32 v95, v66, v67
    v_cvt_pk_bf16_f32 v96, v68, v69
    v_cvt_pk_bf16_f32 v97, v70, v71
    v_cvt_pk_bf16_f32 v98, v72, v73
    v_cvt_pk_bf16_f32 v99, v74, v75
    s_mov_b32 s78, 65536
    v_permlane16_swap_b32 v92, v94
    v_permlane16_swap_b32 v93, v95
    v_permlane16_swap_b32 v96, v98
    v_permlane16_swap_b32 v97, v99
    buffer_store_dwordx4 v[92:95], v18, s[52:55], s78 offen sc1
    buffer_store_dwordx4 v[96:99], v19, s[52:55], s78 offen sc1
    ds_write_b128 v50, v[92:95]
    ds_write_b128 v51, v[96:99]
    s_getpc_b64 s[22:23]
L_ca12:
    v_min_u32 v237, L_code_end-L_ca12-128, v239
    global_load_dword v254, v237, s[22:23]
    s_add_u32 m0, s76, 69632
    s_mul_i32 s77, s80, 176128
    s_add_u32 s77, s77, s92
    buffer_load_dwordx4 v15, s[40:43], s77 offen lds
    s_add_u32 m0, s76, 77696
    s_nop 0
    buffer_load_dwordx4 v15, s[40:43], s77 offen offset:128 lds
    s_add_u32 m0, s76, 89856
    s_nop 0
    buffer_load_dwordx4 v16, s[40:43], s77 offen offset:256 lds
    v_lshlrev_b32 v68, 16, v32
    v_and_b32 v69, s27, v32
    v_lshlrev_b32 v70, 16, v33
    v_and_b32 v71, s27, v33
    v_lshlrev_b32 v72, 16, v34
    v_and_b32 v73, s27, v34
    v_lshlrev_b32 v74, 16, v35
    v_and_b32 v75, s27, v35
    s_add_u32 m0, s76, 131072
    s_mul_i32 s77, s80, 176128
    s_add_u32 s77, s77, s93
    buffer_load_dwordx4 v15, s[40:43], s77 offen lds
    v_lshlrev_b32 v76, 16, v36
    v_and_b32 v77, s27, v36
    v_lshlrev_b32 v78, 16, v37
    v_and_b32 v79, s27, v37
    v_lshlrev_b32 v80, 16, v38
    v_and_b32 v81, s27, v38
    v_lshlrev_b32 v82, 16, v39
    v_and_b32 v83, s27, v39
    s_add_u32 m0, s76, 139136
    s_nop 0
    buffer_load_dwordx4 v15, s[40:43], s77 offen offset:128 lds
    s_add_u32 m0, s76, 122624
    s_nop 0
    buffer_load_dwordx4 v16, s[40:43], s77 offen offset:256 lds
    s_waitcnt lgkmcnt(2)
    s_barrier
    s_add_u32 m0, s76, 65536
    s_mul_i32 s77, s81, 176128
    s_add_u32 s77, s77, s92
    buffer_load_dwordx4 v15, s[40:43], s77 offen lds
    s_add_u32 m0, s76, 73600
    s_nop 0
    buffer_load_dwordx4 v15, s[40:43], s77 offen offset:128 lds
    s_add_u32 m0, s76, 93952
    s_nop 0
    buffer_load_dwordx4 v16, s[40:43], s77 offen offset:256 lds
    s_waitcnt vmcnt(10)
    s_cmp_lg_u32 s10, 0
    s_cbranch_scc1 L_sl13
    buffer_store_dword v12, v251, s[52:55], s11 offen offset:128 sc1
    s_branch L_sd14
L_sl13:
    buffer_store_dword v12, v251, s[52:55], s11 offen offset:128
L_sd14:
    s_waitcnt vmcnt(4)
    s_barrier
    ds_read_b64_tr_b16 a[0:1], v10 offset:4096
    ds_read_b64_tr_b16 a[2:3], v10 offset:4608
    ds_read_b64_tr_b16 a[64:65], v10 offset:12288
    ds_read_b64_tr_b16 a[66:67], v10 offset:12800
    ds_read_b64_tr_b16 a[128:129], v10 offset:24576
    ds_read_b64_tr_b16 a[130:131], v10 offset:25088
    ds_read_b64_tr_b16 a[4:5], v11 offset:0
    ds_read_b64_tr_b16 a[6:7], v11 offset:512
    ds_read_b64_tr_b16 a[68:69], v11 offset:8192
    ds_read_b64_tr_b16 a[70:71], v11 offset:8704
    ds_read_b64_tr_b16 a[132:133], v10 offset:57344
    ds_read_b64_tr_b16 a[134:135], v10 offset:57856
    s_waitcnt lgkmcnt(0)
    s_barrier
    s_barrier
    ds_read_b128 v[100:103], v6 offset:0
    ds_read_b128 v[104:107], v7 offset:0
    ds_read_b128 v[108:111], v8 offset:0
    ds_read_b128 v[112:115], v9 offset:0
    ds_read_b128 v[116:119], v6 offset:4096
    ds_read_b128 v[120:123], v7 offset:4096
    ds_read_b128 v[124:127], v8 offset:4096
    ds_read_b128 v[128:131], v9 offset:4096
    s_waitcnt lgkmcnt(7)
    v_mfma_f32_16x16x32_bf16 v[52:55], a[192:195], v[100:103], 0
    s_waitcnt lgkmcnt(6)
    v_mfma_f32_16x16x32_bf16 v[56:59], a[192:195], v[104:107], 0
    s_waitcnt lgkmcnt(5)
    v_mfma_f32_16x16x32_bf16 v[60:63], a[192:195], v[108:111], 0
    s_waitcnt lgkmcnt(4)
    v_mfma_f32_16x16x32_bf16 v[64:67], a[192:195], v[112:115], 0
    s_waitcnt lgkmcnt(3)
    v_mfma_f32_16x16x32_bf16 v[52:55], a[196:199], v[116:119], v[52:55]
    s_waitcnt lgkmcnt(2)
    v_mfma_f32_16x16x32_bf16 v[56:59], a[196:199], v[120:123], v[56:59]
    s_waitcnt lgkmcnt(1)
    v_mfma_f32_16x16x32_bf16 v[60:63], a[196:199], v[124:127], v[60:63]
    s_waitcnt lgkmcnt(0)
    v_mfma_f32_16x16x32_bf16 v[64:67], a[196:199], v[128:131], v[64:67]
    buffer_load_dword v236, v250, s[52:55], s11 offen offset:128 sc1
    s_add_u32 m0, s76, 69632
    s_mul_i32 s77, s81, 176128
    s_add_u32 s77, s77, s93
    buffer_load_dwordx4 v15, s[40:43], s77 offen lds
    s_add_u32 m0, s76, 77696
    s_nop 0
    buffer_load_dwordx4 v15, s[40:43], s77 offen offset:128 lds
    s_add_u32 m0, s76, 89856
    s_nop 0
    buffer_load_dwordx4 v16, s[40:43], s77 offen offset:256 lds
    s_add_u32 m0, s76, 155648
    s_mul_i32 s77, s82, 176128
    s_add_u32 s77, s77, s92
    buffer_load_dwordx4 v15, s[40:43], s77 offen lds
    s_add_u32 m0, s76, 81792
    s_nop 0
    buffer_load_dwordx4 v15, s[40:43], s77 offen offset:128 lds
    s_add_u32 m0, s76, 85760
    s_nop 0
    buffer_load_dwordx4 v16, s[40:43], s77 offen offset:256 lds
    s_waitcnt vmcnt(6)
    v_cmp_ne_u32 vcc, 1, v236
    s_nop 0
    s_cbranch_vccz L_cf15_x
L_cf15:
    buffer_load_dword v236, v250, s[52:55], s11 offen offset:128 sc1
    s_waitcnt vmcnt(0)
    v_cmp_ne_u32 vcc, 1, v236
    s_nop 0
    s_cbranch_vccz L_cf15_x
    s_add_u32 s79, s79, 1
    s_cmp_lt_u32 s79, 0x200000
    s_cbranch_scc1 L_cf15
L_cf15_x:
    s_add_u32 m0, s101, 8192
    s_lshl_b32 s77, s81, 13
    s_add_u32 s77, s77, s3
    s_add_u32 s77, s77, 65536
    buffer_load_dwordx4 v220, s[52:55], s77 offen sc1 lds
    buffer_load_dwordx4 v220, s[52:55], s77 offen offset:2048 sc1 lds
    s_add_u32 m0, s101, 16384
    s_lshl_b32 s77, s82, 13
    s_add_u32 s77, s77, s3
    s_add_u32 s77, s77, 65536
    buffer_load_dwordx4 v220, s[52:55], s77 offen sc1 lds
    buffer_load_dwordx4 v220, s[52:55], s77 offen offset:2048 sc1 lds
    s_add_u32 m0, s101, 24576
    s_lshl_b32 s77, s83, 13
    s_add_u32 s77, s77, s3
    s_add_u32 s77, s77, 65536
    buffer_load_dwordx4 v220, s[52:55], s77 offen sc1 lds
    buffer_load_dwordx4 v220, s[52:55], s77 offen offset:2048 sc1 lds
    s_add_u32 m0, s101, 32768
    s_lshl_b32 s77, s84, 13
    s_add_u32 s77, s77, s3
    s_add_u32 s77, s77, 65536
    buffer_load_dwordx4 v220, s[52:55], s77 offen sc1 lds
    buffer_load_dwordx4 v220, s[52:55], s77 offen offset:2048 sc1 lds
    s_add_u32 m0, s101, 40960
    s_lshl_b32 s77, s85, 13
    s_add_u32 s77, s77, s3
    s_add_u32 s77, s77, 65536
    buffer_load_dwordx4 v220, s[52:55], s77 offen sc1 lds
    buffer_load_dwordx4 v220, s[52:55], s77 offen offset:2048 sc1 lds
    s_add_u32 m0, s101, 49152
    s_lshl_b32 s77, s86, 13
    s_add_u32 s77, s77, s3
    s_add_u32 s77, s77, 65536
    buffer_load_dwordx4 v220, s[52:55], s77 offen sc1 lds
    buffer_load_dwordx4 v220, s[52:55], s77 offen offset:2048 sc1 lds
    s_waitcnt vmcnt(8)
    s_barrier
    ds_read_b128 v[100:103], v6 offset:8192
    ds_read_b128 v[104:107], v7 offset:8192
    ds_read_b128 v[108:111], v8 offset:8192
    ds_read_b128 v[112:115], v9 offset:8192
    s_waitcnt lgkmcnt(3)
    v_mfma_f32_16x16x32_bf16 v[52:55], a[200:203], v[100:103], v[52:55]
    s_waitcnt lgkmcnt(2)
    ds_read_b128 v[116:119], v6 offset:12288
    s_add_u32 m0, s101, 57344
    v_mfma_f32_16x16x32_bf16 v[56:59], a[200:203], v[104:107], v[56:59]
    s_waitcnt lgkmcnt(2)
    ds_read_b128 v[120:123], v7 offset:12288
    s_lshl_b32 s77, s87, 13
    v_mfma_f32_16x16x32_bf16 v[60:63], a[200:203], v[108:111], v[60:63]
    s_waitcnt lgkmcnt(2)
    ds_read_b128 v[124:127], v8 offset:12288
    s_add_u32 s77, s77, s3
    v_mfma_f32_16x16x32_bf16 v[64:67], a[200:203], v[112:115], v[64:67]
    s_waitcnt lgkmcnt(2)
    ds_read_b128 v[128:131], v9 offset:12288
    s_add_u32 s77, s77, 65536
    v_mfma_f32_16x16x32_bf16 v[52:55], a[204:207], v[116:119], v[52:55]
    s_waitcnt lgkmcnt(2)
    ds_read_b128 v[100:103], v6 offset:16384
    buffer_load_dwordx4 v220, s[52:55], s77 offen sc1 lds
    v_mfma_f32_16x16x32_bf16 v[56:59], a[204:207], v[120:123], v[56:59]
    s_waitcnt lgkmcnt(2)
    ds_read_b128 v[104:107], v7 offset:16384
    buffer_load_dwordx4 v220, s[52:55], s77 offen offset:2048 sc1 lds
    v_mfma_f32_16x16x32_bf16 v[60:63], a[204:207], v[124:127], v[60:63]
    s_waitcnt lgkmcnt(2)
    ds_read_b128 v[108:111], v8 offset:16384
    s_add_u32 m0, s76, 98304
    v_mfma_f32_16x16x32_bf16 v[64:67], a[204:207], v[128:131], v[64:67]
    s_waitcnt lgkmcnt(2)
    ds_read_b128 v[112:115], v9 offset:16384
    s_mul_i32 s77, s82, 176128
    v_mfma_f32_16x16x32_bf16 v[52:55], a[208:211], v[100:103], v[52:55]
    s_waitcnt lgkmcnt(2)
    ds_read_b128 v[116:119], v6 offset:20480
    s_add_u32 s77, s77, s93
    v_mfma_f32_16x16x32_bf16 v[56:59], a[208:211], v[104:107], v[56:59]
    s_waitcnt lgkmcnt(2)
    ds_read_b128 v[120:123], v7 offset:20480
    buffer_load_dwordx4 v15, s[40:43], s77 offen lds
    v_mfma_f32_16x16x32_bf16 v[60:63], a[208:211], v[108:111], v[60:63]
    s_waitcnt lgkmcnt(2)
    ds_read_b128 v[124:127], v8 offset:20480
    s_add_u32 m0, s76, 102272
    v_mfma_f32_16x16x32_bf16 v[64:67], a[208:211], v[112:115], v[64:67]
    s_waitcnt lgkmcnt(2)
    ds_read_b128 v[128:131], v9 offset:20480
    buffer_load_dwordx4 v15, s[40:43], s77 offen offset:128 lds
    s_waitcnt vmcnt(8)
    s_barrier
    v_mfma_f32_16x16x32_bf16 v[52:55], a[212:215], v[116:119], v[52:55]
    s_waitcnt lgkmcnt(2)
    ds_read_b128 v[100:103], v6 offset:24576
    s_add_u32 m0, s76, 106240
    v_mfma_f32_16x16x32_bf16 v[56:59], a[212:215], v[120:123], v[56:59]
    s_waitcnt lgkmcnt(2)
    ds_read_b128 v[104:107], v7 offset:24576
    buffer_load_dwordx4 v16, s[40:43], s77 offen offset:256 lds
    v_mfma_f32_16x16x32_bf16 v[60:63], a[212:215], v[124:127], v[60:63]
    s_waitcnt lgkmcnt(2)
    ds_read_b128 v[108:111], v8 offset:24576
    s_add_u32 m0, s76, 110592
    v_mfma_f32_16x16x32_bf16 v[64:67], a[212:215], v[128:131], v[64:67]
    s_waitcnt lgkmcnt(2)
    ds_read_b128 v[112:115], v9 offset:24576
    s_mul_i32 s77, s83, 176128
    v_mfma_f32_16x16x32_bf16 v[52:55], a[216:219], v[100:103], v[52:55]
    s_waitcnt lgkmcnt(2)
    ds_read_b128 v[116:119], v6 offset:28672
    s_add_u32 s77, s77, s92
    v_mfma_f32_16x16x32_bf16 v[56:59], a[216:219], v[104:107], v[56:59]
    s_waitcnt lgkmcnt(2)
    ds_read_b128 v[120:123], v7 offset:28672
    buffer_load_dwordx4 v15, s[40:43], s77 offen lds
    v_mfma_f32_16x16x32_bf16 v[60:63], a[216:219], v[108:111], v[60:63]
    s_waitcnt lgkmcnt(2)
    ds_read_b128 v[124:127], v8 offset:28672
    s_add_u32 m0, s76, 114560
    v_mfma_f32_16x16x32_bf16 v[64:67], a[216:219], v[112:115], v[64:67]
    s_waitcnt lgkmcnt(2)
    ds_read_b128 v[128:131], v9 offset:28672
    buffer_load_dwordx4 v15, s[40:43], s77 offen offset:128 lds
    v_mfma_f32_16x16x32_bf16 v[52:55], a[220:223], v[116:119], v[52:55]
    s_waitcnt lgkmcnt(2)
    ds_read_b128 v[100:103], v6 offset:32768
    s_add_u32 m0, s76, 118528
    v_mfma_f32_16x16x32_bf16 v[56:59], a[220:223], v[120:123], v[56:59]
    s_waitcnt lgkmcnt(2)
    ds_read_b128 v[104:107], v7 offset:32768
    buffer_load_dwordx4 v16, s[40:43], s77 offen offset:256 lds
    v_mfma_f32_16x16x32_bf16 v[60:63], a[220:223], v[124:127], v[60:63]
    s_waitcnt lgkmcnt(2)
    ds_read_b128 v[108:111], v8 offset:32768
    s_add_u32 m0, s76, 122880
    v_mfma_f32_16x16x32_bf16 v[64:67], a[220:223], v[128:131], v[64:67]
    s_waitcnt lgkmcnt(2)
    ds_read_b128 v[112:115], v9 offset:32768
    s_mul_i32 s77, s83, 176128
    v_mfma_f32_16x16x32_bf16 v[52:55], a[224:227], v[100:103], v[52:55]
    s_waitcnt lgkmcnt(2)
    ds_read_b128 v[116:119], v6 offset:36864
    s_add_u32 s77, s77, s93
    v_mfma_f32_16x16x32_bf16 v[56:59], a[224:227], v[104:107], v[56:59]
    s_waitcnt lgkmcnt(2)
    ds_read_b128 v[120:123], v7 offset:36864
    buffer_load_dwordx4 v15, s[40:43], s77 offen lds
    v_mfma_f32_16x16x32_bf16 v[60:63], a[224:227], v[108:111], v[60:63]
    s_waitcnt lgkmcnt(2)
    ds_read_b128 v[124:127], v8 offset:36864
    s_add_u32 m0, s76, 126848
    v_mfma_f32_16x16x32_bf16 v[64:67], a[224:227], v[112:115], v[64:67]
    s_waitcnt lgkmcnt(2)
    ds_read_b128 v[128:131], v9 offset:36864
    buffer_load_dwordx4 v15, s[40:43], s77 offen offset:128 lds
    s_waitcnt vmcnt(10)
    s_barrier
    v_mfma_f32_16x16x32_bf16 v[52:55], a[228:231], v[116:119], v[52:55]
    s_waitcnt lgkmcnt(2)
    ds_read_b128 v[100:103], v6 offset:40960
    s_add_u32 m0, s76, 130816
    v_mfma_f32_16x16x32_bf16 v[56:59], a[228:231], v[120:123], v[56:59]
    s_waitcnt lgkmcnt(2)
    ds_read_b128 v[104:107], v7 offset:40960
    buffer_load_dwordx4 v16, s[40:43], s77 offen offset:256 lds
    v_mfma_f32_16x16x32_bf16 v[60:63], a[228:231], v[124:127], v[60:63]
    s_waitcnt lgkmcnt(2)
    ds_read_b128 v[108:111], v8 offset:40960
    v_mfma_f32_16x16x32_bf16 v[64:67], a[228:231], v[128:131], v[64:67]
    s_waitcnt lgkmcnt(2)
    ds_read_b128 v[112:115], v9 offset:40960
    v_mfma_f32_16x16x32_bf16 v[52:55], a[232:235], v[100:103], v[52:55]
    s_waitcnt lgkmcnt(2)
    ds_read_b128 v[116:119], v6 offset:45056
    v_mfma_f32_16x16x32_bf16 v[56:59], a[232:235], v[104:107], v[56:59]
    s_waitcnt lgkmcnt(2)
    ds_read_b128 v[120:123], v7 offset:45056
    v_mfma_f32_16x16x32_bf16 v[60:63], a[232:235], v[108:111], v[60:63]
    s_waitcnt lgkmcnt(2)
    ds_read_b128 v[124:127], v8 offset:45056
    v_mfma_f32_16x16x32_bf16 v[64:67], a[232:235], v[112:115], v[64:67]
    s_waitcnt lgkmcnt(2)
    ds_read_b128 v[128:131], v9 offset:45056
    v_mfma_f32_16x16x32_bf16 v[52:55], a[236:239], v[116:119], v[52:55]
    s_waitcnt lgkmcnt(2)
    ds_read_b128 v[100:103], v6 offset:49152
    buffer_load_dword v254, v238, s[44:47], 0 offen offset:384
    v_mfma_f32_16x16x32_bf16 v[56:59], a[236:239], v[120:123], v[56:59]
    s_waitcnt lgkmcnt(2)
    ds_read_b128 v[104:107], v7 offset:49152
    v_mfma_f32_16x16x32_bf16 v[60:63], a[236:239], v[124:127], v[60:63]
    s_waitcnt lgkmcnt(2)
    ds_read_b128 v[108:111], v8 offset:49152
    v_mfma_f32_16x16x32_bf16 v[64:67], a[236:239], v[128:131], v[64:67]
    s_waitcnt lgkmcnt(2)
    ds_read_b128 v[112:115], v9 offset:49152
    v_mfma_f32_16x16x32_bf16 v[52:55], a[240:243], v[100:103], v[52:55]
    s_waitcnt lgkmcnt(2)
    ds_read_b128 v[116:119], v6 offset:53248
    s_add_u32 m0, s76, 135168
    v_mfma_f32_16x16x32_bf16 v[56:59], a[240:243], v[104:107], v[56:59]
    s_waitcnt lgkmcnt(2)
    ds_read_b128 v[120:123], v7 offset:53248
    s_mul_i32 s77, s84, 176128
    v_mfma_f32_16x16x32_bf16 v[60:63], a[240:243], v[108:111], v[60:63]
    s_waitcnt lgkmcnt(2)
    ds_read_b128 v[124:127], v8 offset:53248
    s_add_u32 s77, s77, s92
    v_mfma_f32_16x16x32_bf16 v[64:67], a[240:243], v[112:115], v[64:67]
    s_waitcnt lgkmcnt(2)
    ds_read_b128 v[128:131], v9 offset:53248
    buffer_load_dwordx4 v15, s[40:43], s77 offen lds
    s_waitcnt vmcnt(11)
    s_waitcnt vmcnt(9)
    s_barrier
    v_mfma_f32_16x16x32_bf16 v[52:55], a[244:247], v[116:119], v[52:55]
    s_waitcnt lgkmcnt(2)
    ds_read_b128 v[100:103], v6 offset:57344
    s_add_u32 m0, s76, 139136
    v_mfma_f32_16x16x32_bf16 v[56:59], a[244:247], v[120:123], v[56:59]
    s_waitcnt lgkmcnt(2)
    ds_read_b128 v[104:107], v7 offset:57344
    buffer_load_dwordx4 v15, s[40:43], s77 offen offset:128 lds
    v_mfma_f32_16x16x32_bf16 v[60:63], a[244:247], v[124:127], v[60:63]
    s_waitcnt lgkmcnt(2)
    ds_read_b128 v[108:111], v8 offset:57344
    s_add_u32 m0, s76, 143104
    v_mfma_f32_16x16x32_bf16 v[64:67], a[244:247], v[128:131], v[64:67]
    s_waitcnt lgkmcnt(2)
    ds_read_b128 v[112:115], v9 offset:57344
    buffer_load_dwordx4 v16, s[40:43], s77 offen offset:256 lds
    v_mfma_f32_16x16x32_bf16 v[52:55], a[248:251], v[100:103], v[52:55]
    s_waitcnt lgkmcnt(2)
    ds_read_b128 v[116:119], v6 offset:61440
    v_mfma_f32_16x16x32_bf16 v[56:59], a[248:251], v[104:107], v[56:59]
    s_waitcnt lgkmcnt(2)
    ds_read_b128 v[120:123], v7 offset:61440
    v_mfma_f32_16x16x32_bf16 v[60:63], a[248:251], v[108:111], v[60:63]
    s_waitcnt lgkmcnt(2)
    ds_read_b128 v[124:127], v8 offset:61440
    v_mfma_f32_16x16x32_bf16 v[64:67], a[248:251], v[112:115], v[64:67]
    s_waitcnt lgkmcnt(2)
    ds_read_b128 v[128:131], v9 offset:61440
    v_mfma_f32_16x16x32_bf16 v[52:55], a[252:255], v[116:119], v[52:55]
    s_waitcnt lgkmcnt(2)
    v_mfma_f32_16x16x32_bf16 v[56:59], a[252:255], v[120:123], v[56:59]
    s_waitcnt lgkmcnt(1)
    v_mfma_f32_16x16x32_bf16 v[60:63], a[252:255], v[124:127], v[60:63]
    s_waitcnt lgkmcnt(0)
    v_mfma_f32_16x16x32_bf16 v[64:67], a[252:255], v[128:131], v[64:67]
    s_mov_b32 s78, 0
    s_nop 0
    v_pk_add_f32 v[52:53], v[52:53], v[68:69]
    v_pk_add_f32 v[54:55], v[54:55], v[70:71]
    v_pk_add_f32 v[56:57], v[56:57], v[72:73]
    v_pk_add_f32 v[58:59], v[58:59], v[74:75]
    v_pk_add_f32 v[60:61], v[60:61], v[76:77]
    v_pk_add_f32 v[62:63], v[62:63], v[78:79]
    v_pk_add_f32 v[64:65], v[64:65], v[80:81]
    v_pk_add_f32 v[66:67], v[66:67], v[82:83]
    v_cvt_pk_bf16_f32 v92, v52, v53
    v_cvt_pk_bf16_f32 v93, v54, v55
    v_cvt_pk_bf16_f32 v94, v56, v57
    v_cvt_pk_bf16_f32 v95, v58, v59
    v_cvt_pk_bf16_f32 v96, v60, v61
    v_cvt_pk_bf16_f32 v97, v62, v63
    v_cvt_pk_bf16_f32 v98, v64, v65
    v_cvt_pk_bf16_f32 v99, v66, v67
    v_permlane16_swap_b32 v92, v94
    v_permlane16_swap_b32 v93, v95
    v_permlane16_swap_b32 v96, v98
    v_permlane16_swap_b32 v97, v99
    buffer_store_dwordx4 v[92:95], v18, s[52:55], s78 offen sc1
    buffer_store_dwordx4 v[96:99], v19, s[52:55], s78 offen sc1
    v_pk_add_f32 v[100:101], v[52:53], v[54:55]
    v_pk_mul_f32 v[108:109], v[52:53], v[52:53]
    v_pk_add_f32 v[102:103], v[56:57], v[58:59]
    v_pk_mul_f32 v[110:111], v[56:57], v[56:57]
    v_pk_add_f32 v[104:105], v[60:61], v[62:63]
    v_pk_mul_f32 v[112:113], v[60:61], v[60:61]
    v_pk_add_f32 v[106:107], v[64:65], v[66:67]
    v_pk_mul_f32 v[114:115], v[64:65], v[64:65]
    v_pk_fma_f32 v[108:109], v[54:55], v[54:55], v[108:109]
    v_pk_fma_f32 v[110:111], v[58:59], v[58:59], v[110:111]
    v_pk_fma_f32 v[112:113], v[62:63], v[62:63], v[112:113]
    v_pk_fma_f32 v[114:115], v[66:67], v[66:67], v[114:115]
    v_add_f32 v100, v100, v101
    v_add_f32 v102, v102, v103
    v_add_f32 v104, v104, v105
    v_add_f32 v106, v106, v107
    v_add_f32 v108, v108, v109
    v_add_f32 v110, v110, v111
    v_add_f32 v112, v112, v113
    v_add_f32 v114, v114, v115
    v_permlane16_swap_b32 v100, v102
    v_permlane16_swap_b32 v104, v106
    v_permlane16_swap_b32 v108, v110
    v_permlane16_swap_b32 v112, v114
    v_add_f32 v100, v100, v102
    v_add_f32 v104, v104, v106
    v_add_f32 v108, v108, v110
    v_add_f32 v112, v112, v114
    v_permlane32_swap_b32 v100, v104
    s_nop 0
    v_permlane32_swap_b32 v108, v112
    v_add_f32 v116, v100, v104
    v_add_f32 v117, v108, v112
    buffer_store_dwordx2 v[116:117], v230, s[52:55], s3 offen sc1
    s_waitcnt vmcnt(8)
    s_barrier
    ds_write_b128 v50, v[92:95]
    ds_write_b128 v51, v[96:99]
    s_lshl_b32 s12, s74, 6
    v_xor_b32 v6, s76, v6
    v_xor_b32 v205, s12, v205
    v_xor_b32 v7, s76, v7
    v_xor_b32 v206, s12, v206
    v_xor_b32 v8, s76, v8
    v_xor_b32 v207, s12, v207
    v_xor_b32 v9, s76, v9
    v_xor_b32 v208, s12, v208
    s_getpc_b64 s[22:23]
L_ca16:
    v_min_u32 v237, L_code_end-L_ca16-128, v239
    global_load_dword v254, v237, s[22:23]
    ds_read_b64_tr_b16 a[8:9], v10 offset:0
    ds_read_b64_tr_b16 a[10:11], v10 offset:512
    ds_read_b64_tr_b16 a[72:73], v10 offset:8192
T4:
    s_cbranch_execz L_tret
    ds_read_b64_tr_b16 a[74:75], v10 offset:8704
    ds_read_b64_tr_b16 a[136:137], v10 offset:28672
    ds_read_b64_tr_b16 a[138:139], v10 offset:29184
    ds_read_b64_tr_b16 a[12:13], v10 offset:4096
    ds_read_b64_tr_b16 a[14:15], v10 offset:4608
    ds_read_b64_tr_b16 a[76:77], v10 offset:12288
    ds_read_b64_tr_b16 a[78:79], v10 offset:12800
    ds_read_b64_tr_b16 a[140:141], v10 offset:24576
    ds_read_b64_tr_b16 a[142:143], v10 offset:25088
    ds_read_b64_tr_b16 a[16:17], v11 offset:24576
    ds_read_b64_tr_b16 a[18:19], v11 offset:25088
    ds_read_b64_tr_b16 a[80:81], v10 offset:16384
    ds_read_b64_tr_b16 a[82:83], v10 offset:16896
    ds_read_b64_tr_b16 a[144:145], v10 offset:20480
    ds_read_b64_tr_b16 a[146:147], v10 offset:20992
    ds_read_b64_tr_b16 a[20:21], v10 offset:32768
    ds_read_b64_tr_b16 a[22:23], v10 offset:33280
    ds_read_b64_tr_b16 a[84:85], v10 offset:36864
    ds_read_b64_tr_b16 a[86:87], v10 offset:37376
    ds_read_b64_tr_b16 a[148:149], v10 offset:40960
    ds_read_b64_tr_b16 a[150:151], v10 offset:41472
    ds_read_b64_tr_b16 a[24:25], v10 offset:45056
    ds_read_b64_tr_b16 a[26:27], v10 offset:45568
    ds_read_b64_tr_b16 a[88:89], v10 offset:49152
    ds_read_b64_tr_b16 a[90:91], v10 offset:49664
    ds_read_b64_tr_b16 a[152:153], v10 offset:53248
    ds_read_b64_tr_b16 a[154:155], v10 offset:53760
    ds_read_b64_tr_b16 a[28:29], v10 offset:57344
    ds_read_b64_tr_b16 a[30:31], v10 offset:57856
    ds_read_b64_tr_b16 a[92:93], v10 offset:61440
    ds_read_b64_tr_b16 a[94:95], v10 offset:61952
    v_mfma_f32_16x16x32_bf16 v[164:167], a[0:3], v[24:27], 0
    v_mfma_f32_16x16x32_bf16 v[168:171], a[64:67], v[24:27], 0
    v_mfma_f32_16x16x32_bf16 v[172:175], a[128:131], v[24:27], 0
    v_mfma_f32_16x16x32_bf16 v[164:167], a[4:7], v[24:27], v[164:167]
    v_mfma_f32_16x16x32_bf16 v[168:171], a[68:71], v[24:27], v[168:171]
    v_mfma_f32_16x16x32_bf16 v[172:175], a[132:135], v[24:27], v[172:175]
    s_waitcnt lgkmcnt(15)
    v_mfma_f32_16x16x32_bf16 v[164:167], a[8:11], v[24:27], v[164:167]
    v_mfma_f32_16x16x32_bf16 v[168:171], a[72:75], v[24:27], v[168:171]
    v_mfma_f32_16x16x32_bf16 v[172:175], a[136:139], v[24:27], v[172:175]
    v_mfma_f32_16x16x32_bf16 v[164:167], a[12:15], v[24:27], v[164:167]
    v_mfma_f32_16x16x32_bf16 v[168:171], a[76:79], v[24:27], v[168:171]
    v_mfma_f32_16x16x32_bf16 v[172:175], a[140:143], v[24:27], v[172:175]
    v_mfma_f32_16x16x32_bf16 v[164:167], a[16:19], v[24:27], v[164:167]
    v_mfma_f32_16x16x32_bf16 v[168:171], a[80:83], v[24:27], v[168:171]
    v_mfma_f32_16x16x32_bf16 v[172:175], a[144:147], v[24:27], v[172:175]
    s_waitcnt lgkmcnt(14)
    v_mfma_f32_16x16x32_bf16 v[164:167], a[20:23], v[24:27], v[164:167]
    s_waitcnt lgkmcnt(12)
    v_mfma_f32_16x16x32_bf16 v[168:171], a[84:87], v[24:27], v[168:171]
    s_waitcnt lgkmcnt(10)
    v_mfma_f32_16x16x32_bf16 v[172:175], a[148:151], v[24:27], v[172:175]
    s_waitcnt lgkmcnt(8)
    v_mfma_f32_16x16x32_bf16 v[164:167], a[24:27], v[24:27], v[164:167]
    s_waitcnt lgkmcnt(6)
    v_mfma_f32_16x16x32_bf16 v[168:171], a[88:91], v[24:27], v[168:171]
    s_waitcnt lgkmcnt(4)
    v_mfma_f32_16x16x32_bf16 v[172:175], a[152:155], v[24:27], v[172:175]
    s_waitcnt vmcnt(4)
    s_waitcnt lgkmcnt(0)
    s_barrier
    ds_read_b64_tr_b16 a[156:157], v11 offset:0
    ds_read_b64_tr_b16 a[158:159], v11 offset:512
    ds_read_b64_tr_b16 a[32:33], v11 offset:4096
    ds_read_b64_tr_b16 a[34:35], v11 offset:4608
    ds_read_b64_tr_b16 a[96:97], v11 offset:8192
    ds_read_b64_tr_b16 a[98:99], v11 offset:8704
    ds_read_b64_tr_b16 a[160:161], v11 offset:12288
    ds_read_b64_tr_b16 a[162:163], v11 offset:12800
    s_waitcnt lgkmcnt(0)
    s_barrier
    s_waitcnt vmcnt(1)
    s_cmp_lg_u32 s10, 0
    s_cbranch_scc1 L_sl17
    buffer_store_dword v12, v251, s[52:55], s11 offen offset:256 sc1
    s_branch L_sd18
L_sl17:
    buffer_store_dword v12, v251, s[52:55], s11 offen offset:256
L_sd18:
    v_mfma_f32_16x16x32_bf16 v[164:167], a[28:31], v[24:27], v[164:167]
    v_mfma_f32_16x16x32_bf16 v[168:171], a[92:95], v[24:27], v[168:171]
    v_mfma_f32_16x16x32_bf16 v[172:175], a[156:159], v[24:27], v[172:175]
    v_mfma_f32_16x16x32_bf16 v[164:167], a[32:35], v[24:27], v[164:167]
    v_mfma_f32_16x16x32_bf16 v[168:171], a[96:99], v[24:27], v[168:171]
    v_mfma_f32_16x16x32_bf16 v[172:175], a[160:163], v[24:27], v[172:175]
    s_barrier
    ds_read_b128 v[100:103], v6 offset:0
    ds_read_b128 v[104:107], v7 offset:0
    ds_read_b128 v[108:111], v8 offset:0
    ds_read_b128 v[112:115], v9 offset:0
    s_waitcnt lgkmcnt(3)
    v_mfma_f32_16x16x32_bf16 v[52:55], a[0:3], v[100:103], 0
    ds_read_b128 v[116:119], v6 offset:4096
    v_mfma_f32_16x16x32_bf16 v[60:63], a[64:67], v[100:103], 0
    ds_read_b128 v[120:123], v7 offset:4096
    v_mfma_f32_16x16x32_bf16 v[68:71], a[128:131], v[100:103], 0
    s_waitcnt lgkmcnt(4)
    ds_read_b128 v[124:127], v8 offset:4096
    v_mfma_f32_16x16x32_bf16 v[56:59], a[0:3], v[104:107], 0
    ds_read_b128 v[128:131], v9 offset:4096
    v_mfma_f32_16x16x32_bf16 v[64:67], a[64:67], v[104:107], 0
    v_mfma_f32_16x16x32_bf16 v[72:75], a[128:131], v[104:107], 0
    s_waitcnt lgkmcnt(5)
    v_mfma_f32_16x16x32_bf16 v[76:79], a[0:3], v[108:111], 0
    v_mfma_f32_16x16x32_bf16 v[84:87], a[64:67], v[108:111], 0
    v_mfma_f32_16x16x32_bf16 v[92:95], a[128:131], v[108:111], 0
    s_waitcnt lgkmcnt(4)
    v_mfma_f32_16x16x32_bf16 v[80:83], a[0:3], v[112:115], 0
    v_mfma_f32_16x16x32_bf16 v[88:91], a[64:67], v[112:115], 0
    v_mfma_f32_16x16x32_bf16 v[96:99], a[128:131], v[112:115], 0
    s_waitcnt lgkmcnt(3)
    v_mfma_f32_16x16x32_bf16 v[52:55], a[4:7], v[116:119], v[52:55]
    v_mfma_f32_16x16x32_bf16 v[60:63], a[68:71], v[116:119], v[60:63]
    v_mfma_f32_16x16x32_bf16 v[68:71], a[132:135], v[116:119], v[68:71]
    s_waitcnt lgkmcnt(2)
    v_mfma_f32_16x16x32_bf16 v[56:59], a[4:7], v[120:123], v[56:59]
    v_mfma_f32_16x16x32_bf16 v[64:67], a[68:71], v[120:123], v[64:67]
    v_mfma_f32_16x16x32_bf16 v[72:75], a[132:135], v[120:123], v[72:75]
    s_waitcnt lgkmcnt(1)
    v_mfma_f32_16x16x32_bf16 v[76:79], a[4:7], v[124:127], v[76:79]
    v_mfma_f32_16x16x32_bf16 v[84:87], a[68:71], v[124:127], v[84:87]
    v_mfma_f32_16x16x32_bf16 v[92:95], a[132:135], v[124:127], v[92:95]
    s_waitcnt lgkmcnt(0)
    v_mfma_f32_16x16x32_bf16 v[80:83], a[4:7], v[128:131], v[80:83]
    v_mfma_f32_16x16x32_bf16 v[88:91], a[68:71], v[128:131], v[88:91]
    v_mfma_f32_16x16x32_bf16 v[96:99], a[132:135], v[128:131], v[96:99]
    buffer_load_dword v236, v250, s[52:55], s11 offen offset:256 sc1
    s_add_u32 m0, s76, 155648
    s_mul_i32 s77, s84, 176128
    s_add_u32 s77, s77, s93
    buffer_load_dwordx4 v15, s[40:43], s77 offen lds
    s_add_u32 m0, s76, 65408
    s_nop 0
    buffer_load_dwordx4 v15, s[40:43], s77 offen offset:128 lds
    s_add_u32 m0, s76, 69376
    s_nop 0
    buffer_load_dwordx4 v16, s[40:43], s77 offen offset:256 lds
    s_add_u32 m0, s76, 73728
    s_mul_i32 s77, s85, 176128
    s_add_u32 s77, s77, s92
    buffer_load_dwordx4 v15, s[40:43], s77 offen lds
    s_add_u32 m0, s76, 77696
    s_nop 0
    buffer_load_dwordx4 v15, s[40:43], s77 offen offset:128 lds
    s_add_u32 m0, s76, 81664
    s_nop 0
    buffer_load_dwordx4 v16, s[40:43], s77 offen offset:256 lds
    s_waitcnt vmcnt(6)
    v_cmp_ne_u32 vcc, 1, v236
    s_nop 0
    s_cbranch_vccz L_cf19_x
L_cf19:
    buffer_load_dword v236, v250, s[52:55], s11 offen offset:256 sc1
    s_waitcnt vmcnt(0)
    v_cmp_ne_u32 vcc, 1, v236
    s_nop 0
    s_cbranch_vccz L_cf19_x
    s_add_u32 s79, s79, 1
    s_cmp_lt_u32 s79, 0x200000
    s_cbranch_scc1 L_cf19
L_cf19_x:
    s_add_u32 m0, s101, 8192
    s_lshl_b32 s77, s81, 13
    s_add_u32 s77, s77, s3
    buffer_load_dwordx4 v220, s[52:55], s77 offen sc1 lds
    buffer_load_dwordx4 v220, s[52:55], s77 offen offset:2048 sc1 lds
    s_add_u32 m0, s101, 16384
    s_lshl_b32 s77, s82, 13
    s_add_u32 s77, s77, s3
    buffer_load_dwordx4 v220, s[52:55], s77 offen sc1 lds
    buffer_load_dwordx4 v220, s[52:55], s77 offen offset:2048 sc1 lds
    s_add_u32 m0, s101, 24576
    s_lshl_b32 s77, s83, 13
    s_add_u32 s77, s77, s3
    buffer_load_dwordx4 v220, s[52:55], s77 offen sc1 lds
    buffer_load_dwordx4 v220, s[52:55], s77 offen offset:2048 sc1 lds
    s_add_u32 m0, s101, 32768
    s_lshl_b32 s77, s84, 13
    s_add_u32 s77, s77, s3
    buffer_load_dwordx4 v220, s[52:55], s77 offen sc1 lds
    buffer_load_dwordx4 v220, s[52:55], s77 offen offset:2048 sc1 lds
    s_add_u32 m0, s101, 40960
    s_lshl_b32 s77, s85, 13
    s_add_u32 s77, s77, s3
    buffer_load_dwordx4 v220, s[52:55], s77 offen sc1 lds
    buffer_load_dwordx4 v220, s[52:55], s77 offen offset:2048 sc1 lds
    s_add_u32 m0, s101, 49152
    s_lshl_b32 s77, s86, 13
    s_add_u32 s77, s77, s3
    buffer_load_dwordx4 v220, s[52:55], s77 offen sc1 lds
    buffer_load_dwordx4 v220, s[52:55], s77 offen offset:2048 sc1 lds
    s_add_u32 m0, s101, 57344
    s_lshl_b32 s77, s87, 13
    s_add_u32 s77, s77, s3
    buffer_load_dwordx4 v220, s[52:55], s77 offen sc1 lds
    buffer_load_dwordx4 v220, s[52:55], s77 offen offset:2048 sc1 lds
    s_waitcnt vmcnt(10)
    s_barrier
    ds_read_b128 v[100:103], v6 offset:8192
    ds_read_b128 v[104:107], v7 offset:8192
    ds_read_b128 v[108:111], v8 offset:8192
    ds_read_b128 v[112:115], v9 offset:8192
    s_waitcnt lgkmcnt(3)
    v_mfma_f32_16x16x32_bf16 v[52:55], a[8:11], v[100:103], v[52:55]
    s_add_u32 m0, s76, 86016
    ds_read_b128 v[116:119], v6 offset:12288
    s_mul_i32 s77, s85, 176128
    v_mfma_f32_16x16x32_bf16 v[60:63], a[72:75], v[100:103], v[60:63]
    s_add_u32 s77, s77, s93
    ds_read_b128 v[120:123], v7 offset:12288
    buffer_load_dwordx4 v15, s[40:43], s77 offen lds
    v_mfma_f32_16x16x32_bf16 v[68:71], a[136:139], v[100:103], v[68:71]
    s_waitcnt lgkmcnt(4)
    ds_read_b128 v[124:127], v8 offset:12288
    s_add_u32 m0, s76, 89984
    v_mfma_f32_16x16x32_bf16 v[56:59], a[8:11], v[104:107], v[56:59]
    ds_read_b128 v[128:131], v9 offset:12288
    buffer_load_dwordx4 v15, s[40:43], s77 offen offset:128 lds
    v_mfma_f32_16x16x32_bf16 v[64:67], a[72:75], v[104:107], v[64:67]
    s_add_u32 m0, s76, 93952
    s_nop 0
    buffer_load_dwordx4 v16, s[40:43], s77 offen offset:256 lds
    ds_read_b64_tr_b16 a[36:37], v11 offset:24576
    v_mfma_f32_16x16x32_bf16 v[72:75], a[136:139], v[104:107], v[72:75]
    s_waitcnt lgkmcnt(6)
    ds_read_b64_tr_b16 a[38:39], v11 offset:25088
    v_mfma_f32_16x16x32_bf16 v[76:79], a[8:11], v[108:111], v[76:79]
    ds_read_b64_tr_b16 a[100:101], v10 offset:0
    v_mfma_f32_16x16x32_bf16 v[84:87], a[72:75], v[108:111], v[84:87]
    ds_read_b64_tr_b16 a[102:103], v10 offset:512
    v_mfma_f32_16x16x32_bf16 v[92:95], a[136:139], v[108:111], v[92:95]
    s_waitcnt lgkmcnt(8)
    s_add_u32 m0, s76, 98304
    s_mul_i32 s77, s86, 176128
    v_mfma_f32_16x16x32_bf16 v[80:83], a[8:11], v[112:115], v[80:83]
    s_add_u32 s77, s77, s92
    buffer_load_dwordx4 v15, s[40:43], s77 offen lds
    s_add_u32 m0, s76, 102272
    v_mfma_f32_16x16x32_bf16 v[88:91], a[72:75], v[112:115], v[88:91]
    buffer_load_dwordx4 v15, s[40:43], s77 offen offset:128 lds
    s_add_u32 m0, s76, 106240
    v_mfma_f32_16x16x32_bf16 v[96:99], a[136:139], v[112:115], v[96:99]
    s_waitcnt lgkmcnt(7)
    buffer_load_dwordx4 v16, s[40:43], s77 offen offset:256 lds
    ds_read_b64_tr_b16 a[164:165], v10 offset:4096
    v_mfma_f32_16x16x32_bf16 v[52:55], a[12:15], v[116:119], v[52:55]
    ds_read_b128 v[100:103], v6 offset:16384
    v_mfma_f32_16x16x32_bf16 v[60:63], a[76:79], v[116:119], v[60:63]
    ds_read_b128 v[104:107], v7 offset:16384
    v_mfma_f32_16x16x32_bf16 v[68:71], a[140:143], v[116:119], v[68:71]
    s_waitcnt lgkmcnt(9)
    ds_read_b128 v[108:111], v8 offset:16384
    v_mfma_f32_16x16x32_bf16 v[56:59], a[12:15], v[120:123], v[56:59]
    ds_read_b128 v[112:115], v9 offset:16384
    v_mfma_f32_16x16x32_bf16 v[64:67], a[76:79], v[120:123], v[64:67]
    ds_read_b64_tr_b16 a[166:167], v10 offset:4608
    v_mfma_f32_16x16x32_bf16 v[72:75], a[140:143], v[120:123], v[72:75]
    s_waitcnt lgkmcnt(11)
    ds_read_b64_tr_b16 a[40:41], v10 offset:8192
    v_mfma_f32_16x16x32_bf16 v[76:79], a[12:15], v[124:127], v[76:79]
    ds_read_b64_tr_b16 a[42:43], v10 offset:8704
    v_mfma_f32_16x16x32_bf16 v[84:87], a[76:79], v[124:127], v[84:87]
    ds_read_b64_tr_b16 a[104:105], v10 offset:12288
    v_mfma_f32_16x16x32_bf16 v[92:95], a[140:143], v[124:127], v[92:95]
    s_waitcnt lgkmcnt(13)
    ds_read_b64_tr_b16 a[106:107], v10 offset:12800
    v_mfma_f32_16x16x32_bf16 v[80:83], a[12:15], v[128:131], v[80:83]
    ds_read_b64_tr_b16 a[168:169], v10 offset:16384
    v_mfma_f32_16x16x32_bf16 v[88:91], a[76:79], v[128:131], v[88:91]
    ds_read_b64_tr_b16 a[170:171], v10 offset:16896
    v_mfma_f32_16x16x32_bf16 v[96:99], a[140:143], v[128:131], v[96:99]
    s_waitcnt lgkmcnt(10)
    v_mfma_f32_16x16x32_bf16 v[52:55], a[16:19], v[100:103], v[52:55]
    ds_read_b128 v[116:119], v6 offset:20480
    v_mfma_f32_16x16x32_bf16 v[60:63], a[80:83], v[100:103], v[60:63]
    ds_read_b128 v[120:123], v7 offset:20480
    v_mfma_f32_16x16x32_bf16 v[68:71], a[144:147], v[100:103], v[68:71]
    s_waitcnt lgkmcnt(11)
    ds_read_b128 v[124:127], v8 offset:20480
    v_mfma_f32_16x16x32_bf16 v[56:59], a[16:19], v[104:107], v[56:59]
    ds_read_b128 v[128:131], v9 offset:20480
    v_mfma_f32_16x16x32_bf16 v[64:67], a[80:83], v[104:107], v[64:67]
    v_mfma_f32_16x16x32_bf16 v[72:75], a[144:147], v[104:107], v[72:75]
    s_waitcnt lgkmcnt(12)
    v_mfma_f32_16x16x32_bf16 v[76:79], a[16:19], v[108:111], v[76:79]
    v_mfma_f32_16x16x32_bf16 v[84:87], a[80:83], v[108:111], v[84:87]
    v_mfma_f32_16x16x32_bf16 v[92:95], a[144:147], v[108:111], v[92:95]
    s_waitcnt lgkmcnt(11)
    buffer_load_dwordx2 v[136:137], v22, s[52:55], s3 offen offset:0 sc1
    buffer_load_dwordx2 v[138:139], v22, s[52:55], s3 offen offset:512 sc1
    v_mfma_f32_16x16x32_bf16 v[80:83], a[16:19], v[112:115], v[80:83]
    buffer_load_dwordx2 v[140:141], v22, s[52:55], s3 offen offset:1024 sc1
    buffer_load_dwordx2 v[142:143], v22, s[52:55], s3 offen offset:1536 sc1
    v_mfma_f32_16x16x32_bf16 v[88:91], a[80:83], v[112:115], v[88:91]
    buffer_load_dwordx2 v[144:145], v22, s[52:55], s3 offen offset:2048 sc1
    buffer_load_dwordx2 v[146:147], v22, s[52:55], s3 offen offset:2560 sc1
    v_mfma_f32_16x16x32_bf16 v[96:99], a[144:147], v[112:115], v[96:99]
    s_waitcnt lgkmcnt(3)
    buffer_load_dwordx2 v[148:149], v22, s[52:55], s3 offen offset:3072 sc1
    buffer_load_dwordx2 v[150:151], v22, s[52:55], s3 offen offset:3584 sc1
    s_waitcnt vmcnt(20)
    s_waitcnt vmcnt(13)
    s_barrier
    v_mfma_f32_16x16x32_bf16 v[52:55], a[20:23], v[116:119], v[52:55]
    s_add_u32 m0, s76, 81920
    ds_read_b128 v[100:103], v6 offset:24576
    s_mul_i32 s77, s86, 176128
    v_mfma_f32_16x16x32_bf16 v[60:63], a[84:87], v[116:119], v[60:63]
    s_add_u32 s77, s77, s93
    ds_read_b128 v[104:107], v7 offset:24576
    buffer_load_dwordx4 v15, s[40:43], s77 offen lds
    v_mfma_f32_16x16x32_bf16 v[68:71], a[148:151], v[116:119], v[68:71]
    s_waitcnt lgkmcnt(4)
    ds_read_b128 v[108:111], v8 offset:24576
    s_add_u32 m0, s76, 110464
    v_mfma_f32_16x16x32_bf16 v[56:59], a[20:23], v[120:123], v[56:59]
    ds_read_b128 v[112:115], v9 offset:24576
    buffer_load_dwordx4 v15, s[40:43], s77 offen offset:128 lds
    v_mfma_f32_16x16x32_bf16 v[64:67], a[84:87], v[120:123], v[64:67]
    s_add_u32 m0, s76, 155392
    s_nop 0
    buffer_load_dwordx4 v16, s[40:43], s77 offen offset:256 lds
    ds_read_b64_tr_b16 a[44:45], v10 offset:20480
    v_mfma_f32_16x16x32_bf16 v[72:75], a[148:151], v[120:123], v[72:75]
    s_waitcnt lgkmcnt(6)
    ds_read_b64_tr_b16 a[46:47], v10 offset:20992
    v_mfma_f32_16x16x32_bf16 v[76:79], a[20:23], v[124:127], v[76:79]
    v_mfma_f32_16x16x32_bf16 v[84:87], a[84:87], v[124:127], v[84:87]
    v_mfma_f32_16x16x32_bf16 v[92:95], a[148:151], v[124:127], v[92:95]
    s_waitcnt lgkmcnt(6)
    s_add_u32 m0, s76, 65536
    s_mul_i32 s77, s87, 176128
    v_mfma_f32_16x16x32_bf16 v[80:83], a[20:23], v[128:131], v[80:83]
    s_add_u32 s77, s77, s92
    buffer_load_dwordx4 v15, s[40:43], s77 offen lds
    s_add_u32 m0, s76, 69504
    v_mfma_f32_16x16x32_bf16 v[88:91], a[84:87], v[128:131], v[88:91]
    buffer_load_dwordx4 v15, s[40:43], s77 offen offset:128 lds
    s_add_u32 m0, s76, 73472
    v_mfma_f32_16x16x32_bf16 v[96:99], a[148:151], v[128:131], v[96:99]
    s_waitcnt lgkmcnt(5)
    buffer_load_dwordx4 v16, s[40:43], s77 offen offset:256 lds
    v_mfma_f32_16x16x32_bf16 v[52:55], a[24:27], v[100:103], v[52:55]
    v_mfma_f32_16x16x32_bf16 v[60:63], a[88:91], v[100:103], v[60:63]
    v_mfma_f32_16x16x32_bf16 v[68:71], a[152:155], v[100:103], v[68:71]
    s_waitcnt lgkmcnt(4)
    v_mfma_f32_16x16x32_bf16 v[56:59], a[24:27], v[104:107], v[56:59]
    v_mfma_f32_16x16x32_bf16 v[64:67], a[88:91], v[104:107], v[64:67]
    v_mfma_f32_16x16x32_bf16 v[72:75], a[152:155], v[104:107], v[72:75]
    s_waitcnt lgkmcnt(3)
    v_mfma_f32_16x16x32_bf16 v[76:79], a[24:27], v[108:111], v[76:79]
    v_mfma_f32_16x16x32_bf16 v[84:87], a[88:91], v[108:111], v[84:87]
    v_mfma_f32_16x16x32_bf16 v[92:95], a[152:155], v[108:111], v[92:95]
    s_waitcnt lgkmcnt(2)
    v_mfma_f32_16x16x32_bf16 v[80:83], a[24:27], v[112:115], v[80:83]
    v_mfma_f32_16x16x32_bf16 v[88:91], a[88:91], v[112:115], v[88:91]
    v_mfma_f32_16x16x32_bf16 v[96:99], a[152:155], v[112:115], v[96:99]
    s_add_u32 m0, s76, 77824
    s_mul_i32 s77, s87, 176128
    s_add_u32 s77, s77, s93
    ds_read_b128 v[116:119], v6 offset:28672
    ds_read_b128 v[120:123], v7 offset:28672
    s_waitcnt lgkmcnt(1)
    v_mfma_f32_16x16x32_bf16 v[52:55], a[28:31], v[116:119], v[52:55]
    ds_read_b128 v[100:103], v6 offset:32768
    buffer_load_dwordx4 v15, s[40:43], s77 offen lds
    v_mfma_f32_16x16x32_bf16 v[60:63], a[92:95], v[116:119], v[60:63]
    s_add_u32 m0, s76, 114560
    ds_read_b128 v[104:107], v7 offset:32768
    buffer_load_dwordx4 v15, s[40:43], s77 offen offset:128 lds
    v_mfma_f32_16x16x32_bf16 v[68:71], a[156:159], v[116:119], v[68:71]
    s_waitcnt lgkmcnt(2)
    s_add_u32 m0, s76, 118528
    s_nop 0
    buffer_load_dwordx4 v16, s[40:43], s77 offen offset:256 lds
    v_mfma_f32_16x16x32_bf16 v[56:59], a[28:31], v[120:123], v[56:59]
    s_waitcnt vmcnt(12)
    v_add_f32 v136, v136, v144
    v_add_f32 v137, v137, v145
    v_mfma_f32_16x16x32_bf16 v[64:67], a[92:95], v[120:123], v[64:67]
    s_waitcnt vmcnt(11)
    v_add_f32 v138, v138, v146
    v_add_f32 v139, v139, v147
    v_mfma_f32_16x16x32_bf16 v[72:75], a[156:159], v[120:123], v[72:75]
    s_waitcnt lgkmcnt(1)
    s_waitcnt vmcnt(10)
    v_add_f32 v140, v140, v148
    v_add_f32 v141, v141, v149
    v_mfma_f32_16x16x32_bf16 v[52:55], a[32:35], v[100:103], v[52:55]
    ds_read_b128 v[116:119], v6 offset:36864
    s_waitcnt vmcnt(9)
    v_add_f32 v142, v142, v150
    v_mfma_f32_16x16x32_bf16 v[60:63], a[96:99], v[100:103], v[60:63]
    ds_read_b128 v[120:123], v7 offset:36864
    v_add_f32 v143, v143, v151
    v_mfma_f32_16x16x32_bf16 v[68:71], a[160:163], v[100:103], v[68:71]
    s_waitcnt lgkmcnt(2)
    v_add_f32 v136, v136, v140
    v_add_f32 v137, v137, v141
    v_mfma_f32_16x16x32_bf16 v[56:59], a[32:35], v[104:107], v[56:59]
    v_add_f32 v138, v138, v142
    v_add_f32 v139, v139, v143
    v_mfma_f32_16x16x32_bf16 v[64:67], a[96:99], v[104:107], v[64:67]
    v_add_f32 v136, v136, v138
    v_add_f32 v137, v137, v139
    v_mfma_f32_16x16x32_bf16 v[72:75], a[160:163], v[104:107], v[72:75]
    s_waitcnt lgkmcnt(1)
    v_mov_b32 v138, v136
    v_mov_b32 v139, v137
    s_barrier
    v_mfma_f32_16x16x32_bf16 v[52:55], a[36:39], v[116:119], v[52:55]
    s_add_u32 m0, s59, 122880
    ds_read_b128 v[100:103], v6 offset:40960
    s_lshl_b32 s77, s0, 14
    v_mfma_f32_16x16x32_bf16 v[60:63], a[100:103], v[116:119], v[60:63]
    s_add_u32 s77, s77, s90
    ds_read_b128 v[104:107], v7 offset:40960
    buffer_load_dwordx4 v21, s[44:47], s77 offen lds
    v_mfma_f32_16x16x32_bf16 v[68:71], a[164:167], v[116:119], v[68:71]
    s_waitcnt lgkmcnt(2)
    buffer_load_dwordx4 v228, s[44:47], s77 offen offset:1024 lds
    v_permlane16_swap_b32 v136, v138
    v_mfma_f32_16x16x32_bf16 v[56:59], a[36:39], v[120:123], v[56:59]
    v_permlane16_swap_b32 v137, v139
    v_add_f32 v136, v136, v138
    v_mfma_f32_16x16x32_bf16 v[64:67], a[100:103], v[120:123], v[64:67]
    s_add_u32 m0, s59, 131072
    s_lshl_b32 s77, s0, 14
    s_add_u32 s77, s77, s90
    v_mfma_f32_16x16x32_bf16 v[72:75], a[164:167], v[120:123], v[72:75]
    s_add_u32 s77, s77, 65536
    buffer_load_dwordx4 v21, s[44:47], s77 offen lds
    buffer_load_dwordx4 v228, s[44:47], s77 offen offset:1024 lds
    v_mfma_f32_16x16x32_bf16 v[164:167], a[36:39], v[24:27], v[164:167]
    v_add_f32 v137, v137, v139
    v_mov_b32 v138, v136
    v_mfma_f32_16x16x32_bf16 v[168:171], a[100:103], v[24:27], v[168:171]
    v_mov_b32 v139, v137
    v_permlane32_swap_b32 v136, v138
    v_mfma_f32_16x16x32_bf16 v[172:175], a[164:167], v[24:27], v[172:175]
    s_waitcnt lgkmcnt(1)
    v_permlane32_swap_b32 v137, v139
    v_add_f32 v136, v136, v138
    ds_read_b64_tr_b16 a[108:109], v10 offset:24576
    ds_read_b64_tr_b16 a[110:111], v10 offset:25088
    ds_read_b64_tr_b16 a[172:173], v10 offset:28672
    ds_read_b64_tr_b16 a[174:175], v10 offset:29184
    v_mfma_f32_16x16x32_bf16 v[52:55], a[40:43], v[100:103], v[52:55]
    ds_read_b128 v[116:119], v6 offset:45056
    v_add_f32 v137, v137, v139
    v_mfma_f32_16x16x32_bf16 v[60:63], a[104:107], v[100:103], v[60:63]
    s_add_u32 m0, s59, 139264
    ds_read_b128 v[120:123], v7 offset:45056
    s_lshl_b32 s77, s61, 14
    v_mfma_f32_16x16x32_bf16 v[68:71], a[168:171], v[100:103], v[68:71]
    s_waitcnt lgkmcnt(6)
    s_add_u32 s77, s77, s90
    buffer_load_dwordx4 v21, s[44:47], s77 offen lds
    v_mfma_f32_16x16x32_bf16 v[56:59], a[40:43], v[104:107], v[56:59]
    buffer_load_dwordx4 v228, s[44:47], s77 offen offset:1024 lds
    v_mul_f32 v153, 0x3b000000, v136
    v_mfma_f32_16x16x32_bf16 v[64:67], a[104:107], v[104:107], v[64:67]
    v_mul_f32 v152, 0x3b000000, v137
    v_mul_f32 v159, v153, v153
    v_mfma_f32_16x16x32_bf16 v[72:75], a[168:171], v[104:107], v[72:75]
    v_sub_f32 v154, v152, v159
    v_max_f32 v154, 0, v154
    v_mfma_f32_16x16x32_bf16 v[164:167], a[40:43], v[24:27], v[164:167]
    v_cvt_pk_bf16_f32 v159, v153, v154
    v_and_b32 v156, s27, v159
    v_mfma_f32_16x16x32_bf16 v[168:171], a[104:107], v[24:27], v[168:171]
    v_lshlrev_b32 v155, 16, v159
    v_add_f32 v156, 0x3727c5ac, v156
    v_mfma_f32_16x16x32_bf16 v[172:175], a[168:171], v[24:27], v[172:175]
    s_waitcnt lgkmcnt(1)
    v_cvt_pk_bf16_f32 v159, v156, v156
    v_lshlrev_b32 v156, 16, v159
    ds_read_b64_tr_b16 a[48:49], v10 offset:32768
    ds_read_b64_tr_b16 a[50:51], v10 offset:33280
    ds_read_b64_tr_b16 a[112:113], v10 offset:36864
    ds_read_b64_tr_b16 a[114:115], v10 offset:37376
    ds_read_b64_tr_b16 a[176:177], v10 offset:40960
    ds_read_b64_tr_b16 a[178:179], v10 offset:41472
    v_mfma_f32_16x16x32_bf16 v[52:55], a[44:47], v[116:119], v[52:55]
    s_add_u32 m0, s59, 147456
    ds_read_b128 v[100:103], v6 offset:49152
    s_lshl_b32 s77, s1, 14
    v_mfma_f32_16x16x32_bf16 v[60:63], a[108:111], v[116:119], v[60:63]
    s_add_u32 s77, s77, s90
    ds_read_b128 v[104:107], v7 offset:49152
    buffer_load_dwordx4 v21, s[44:47], s77 offen lds
    v_mfma_f32_16x16x32_bf16 v[68:71], a[172:175], v[116:119], v[68:71]
    s_waitcnt lgkmcnt(8)
    buffer_load_dwordx4 v228, s[44:47], s77 offen offset:1024 lds
    v_sub_f32 v160, v153, v155
    v_mfma_f32_16x16x32_bf16 v[56:59], a[44:47], v[120:123], v[56:59]
    v_sqrt_f32 v157, v156
    v_mfma_f32_16x16x32_bf16 v[64:67], a[108:111], v[120:123], v[64:67]
    v_cvt_pk_bf16_f32 v159, v157, v157
    v_lshlrev_b32 v157, 16, v159
    v_mfma_f32_16x16x32_bf16 v[72:75], a[172:175], v[120:123], v[72:75]
    v_rcp_f32 v158, v157
    v_mfma_f32_16x16x32_bf16 v[164:167], a[44:47], v[24:27], v[164:167]
    s_nop 0
    v_mul_f32 v159, v160, v158
    v_mul_f32 v160, v154, v158
    v_mfma_f32_16x16x32_bf16 v[168:171], a[108:111], v[24:27], v[168:171]
    v_mul_f32 v160, v160, v158
    v_cvt_pk_bf16_f32 v152, v159, v160
    v_mfma_f32_16x16x32_bf16 v[172:175], a[172:175], v[24:27], v[172:175]
    s_waitcnt lgkmcnt(1)
    v_and_b32 v160, s27, v152
    v_lshlrev_b32 v159, 16, v152
    s_waitcnt vmcnt(14)
    s_waitcnt vmcnt(11)
    s_barrier
    ds_read_b64_tr_b16 a[52:53], v10 offset:16384
    ds_read_b64_tr_b16 a[54:55], v10 offset:16896
    ds_read_b64_tr_b16 a[116:117], v10 offset:45056
    ds_read_b64_tr_b16 a[118:119], v10 offset:45568
    ds_read_b64_tr_b16 a[180:181], v11 offset:24576
    ds_read_b64_tr_b16 a[182:183], v11 offset:25088
    v_mfma_f32_16x16x32_bf16 v[52:55], a[48:51], v[100:103], v[52:55]
    ds_read_b128 v[116:119], v6 offset:53248
    v_add_f32 v160, 0x3727c5ac, v160
    v_mfma_f32_16x16x32_bf16 v[60:63], a[112:115], v[100:103], v[60:63]
    ds_read_b128 v[120:123], v7 offset:53248
    v_cvt_pk_bf16_f32 v152, v160, v160
    v_mfma_f32_16x16x32_bf16 v[68:71], a[176:179], v[100:103], v[68:71]
    s_waitcnt lgkmcnt(8)
    v_lshlrev_b32 v160, 16, v152
    v_fmac_f32 v159, v155, v158
    v_mfma_f32_16x16x32_bf16 v[56:59], a[48:51], v[104:107], v[56:59]
    v_sqrt_f32 v160, v160
    v_mfma_f32_16x16x32_bf16 v[64:67], a[112:115], v[104:107], v[64:67]
    v_cvt_pk_bf16_f32 v152, v160, v160
    v_lshlrev_b32 v160, 16, v152
    v_mfma_f32_16x16x32_bf16 v[72:75], a[176:179], v[104:107], v[72:75]
    s_add_u32 m0, s59, 90112
    s_lshl_b32 s77, s1, 14
    s_add_u32 s77, s77, s90
    v_mfma_f32_16x16x32_bf16 v[164:167], a[48:51], v[24:27], v[164:167]
    s_add_u32 s77, s77, 65536
    buffer_load_dwordx4 v21, s[44:47], s77 offen lds
    buffer_load_dwordx4 v228, s[44:47], s77 offen offset:1024 lds
    v_mfma_f32_16x16x32_bf16 v[168:171], a[112:115], v[24:27], v[168:171]
    v_rcp_f32 v160, v160
    v_mfma_f32_16x16x32_bf16 v[172:175], a[176:179], v[24:27], v[172:175]
    s_waitcnt lgkmcnt(1)
    s_nop 0
    v_mul_f32 v161, v158, v160
    ds_read_b64_tr_b16 a[56:57], v10 offset:0
    ds_read_b64_tr_b16 a[58:59], v10 offset:512
    ds_read_b64_tr_b16 a[120:121], v10 offset:4096
    ds_read_b64_tr_b16 a[122:123], v10 offset:4608
    ds_read_b64_tr_b16 a[184:185], v10 offset:8192
    ds_read_b64_tr_b16 a[186:187], v10 offset:8704
    v_mfma_f32_16x16x32_bf16 v[52:55], a[52:55], v[116:119], v[52:55]
    ds_read_b128 v[100:103], v6 offset:57344
    v_mul_f32_e64 v162, -v159, v160
    v_mfma_f32_16x16x32_bf16 v[60:63], a[116:119], v[116:119], v[60:63]
    ds_read_b128 v[104:107], v7 offset:57344
    v_mfma_f32_16x16x32_bf16 v[68:71], a[180:183], v[116:119], v[68:71]
    s_waitcnt lgkmcnt(8)
    s_add_u32 m0, s59, 98304
    s_lshl_b32 s77, s62, 14
    v_mfma_f32_16x16x32_bf16 v[56:59], a[52:55], v[120:123], v[56:59]
    s_add_u32 s77, s77, s90
    buffer_load_dwordx4 v21, s[44:47], s77 offen lds
    buffer_load_dwordx4 v228, s[44:47], s77 offen offset:1024 lds
    v_mfma_f32_16x16x32_bf16 v[64:67], a[116:119], v[120:123], v[64:67]
    s_mov_b64 exec, s[16:17]
    ds_write2_b32 v200, v161, v162 offset0:0 offset1:64
    s_mov_b64 exec, -1
    v_mfma_f32_16x16x32_bf16 v[72:75], a[180:183], v[120:123], v[72:75]
    v_mfma_f32_16x16x32_bf16 v[164:167], a[52:55], v[24:27], v[164:167]
    v_mfma_f32_16x16x32_bf16 v[168:171], a[116:119], v[24:27], v[168:171]
    v_mfma_f32_16x16x32_bf16 v[172:175], a[180:183], v[24:27], v[172:175]
    s_waitcnt lgkmcnt(2)
    s_waitcnt vmcnt(10)
    ds_read_b64_tr_b16 a[192:193], v226 offset:57344
    s_waitcnt lgkmcnt(1)
    s_barrier
    ds_read_b64_tr_b16 a[194:195], v226 offset:57856
    ds_read_b64_tr_b16 a[196:197], v226 offset:57600
    ds_read_b64_tr_b16 a[198:199], v226 offset:58112
    ds_read_b64_tr_b16 a[60:61], v10 offset:12288
    ds_read_b64_tr_b16 a[62:63], v10 offset:12800
    ds_read_b64_tr_b16 a[124:125], v10 offset:49152
    ds_read_b64_tr_b16 a[126:127], v10 offset:49664
    ds_read_b64_tr_b16 a[188:189], v10 offset:53248
    ds_read_b64_tr_b16 a[190:191], v10 offset:53760
    v_mfma_f32_16x16x32_bf16 v[52:55], a[56:59], v[100:103], v[52:55]
    s_add_u32 m0, s59, 65536
    ds_read_b128 v[116:119], v6 offset:61440
    s_lshl_b32 s77, s13, 14
    v_mfma_f32_16x16x32_bf16 v[60:63], a[120:123], v[100:103], v[60:63]
    s_add_u32 s77, s77, s90
    ds_read_b128 v[120:123], v7 offset:61440
    buffer_load_dwordx4 v21, s[44:47], s77 offen lds
    v_mfma_f32_16x16x32_bf16 v[68:71], a[184:187], v[100:103], v[68:71]
    ds_read2_b32 v[176:177], v205 offset0:0 offset1:64
    buffer_load_dwordx4 v228, s[44:47], s77 offen offset:1024 lds
    v_mfma_f32_16x16x32_bf16 v[56:59], a[56:59], v[104:107], v[56:59]
T5:
    s_cbranch_execz L_tret
    s_add_u32 m0, s59, 81920
    ds_read2_b32 v[178:179], v206 offset0:0 offset1:64
    s_lshl_b32 s77, s13, 14
    v_mfma_f32_16x16x32_bf16 v[64:67], a[120:123], v[104:107], v[64:67]
    s_add_u32 s77, s77, s90
    ds_read2_b32 v[180:181], v207 offset0:0 offset1:64
    s_add_u32 s77, s77, 65536
    v_mfma_f32_16x16x32_bf16 v[72:75], a[184:187], v[104:107], v[72:75]
    ds_read2_b32 v[182:183], v208 offset0:0 offset1:64
    buffer_load_dwordx4 v21, s[44:47], s77 offen lds
    v_mfma_f32_16x16x32_bf16 v[164:167], a[56:59], v[24:27], v[164:167]
    buffer_load_dwordx4 v228, s[44:47], s77 offen offset:1024 lds
    s_waitcnt vmcnt(12)
    ds_read_b64_tr_b16 a[200:201], v227 offset:0
    v_mfma_f32_16x16x32_bf16 v[168:171], a[120:123], v[24:27], v[168:171]
    ds_read_b64_tr_b16 a[202:203], v227 offset:512
    v_mfma_f32_16x16x32_bf16 v[172:175], a[184:187], v[24:27], v[172:175]
    s_waitcnt lgkmcnt(7)
    ds_read_b64_tr_b16 a[204:205], v227 offset:256
    v_mfma_f32_16x16x32_bf16 v[52:55], a[60:63], v[116:119], v[52:55]
    ds_read_b64_tr_b16 a[206:207], v227 offset:768
    v_mfma_f32_16x16x32_bf16 v[60:63], a[124:127], v[116:119], v[60:63]
    v_mfma_f32_16x16x32_bf16 v[68:71], a[188:191], v[116:119], v[68:71]
    s_waitcnt lgkmcnt(8)
    v_mfma_f32_16x16x32_bf16 v[56:59], a[60:63], v[120:123], v[56:59]
    v_mfma_f32_16x16x32_bf16 v[64:67], a[124:127], v[120:123], v[64:67]
    v_mfma_f32_16x16x32_bf16 v[72:75], a[188:191], v[120:123], v[72:75]
    v_mfma_f32_16x16x32_bf16 v[164:167], a[60:63], v[24:27], v[164:167]
    v_mfma_f32_16x16x32_bf16 v[168:171], a[124:127], v[24:27], v[168:171]
    v_mfma_f32_16x16x32_bf16 v[172:175], a[188:191], v[24:27], v[172:175]
    .p2align 3
    v_lshlrev_b32 v232, 16, v40
    v_and_b32 v233, s27, v40
    v_lshlrev_b32 v234, 16, v41
    v_and_b32 v235, s27, v41
    s_waitcnt lgkmcnt(7)
    s_nop 0
    v_pk_fma_f32 v[100:101], v[164:165], v[176:177], v[232:233] op_sel:[0,1,0] op_sel_hi:[1,1,1]
    v_pk_fma_f32 v[102:103], v[166:167], v[176:177], v[234:235] op_sel:[0,1,0] op_sel_hi:[1,1,1]
    s_waitcnt lgkmcnt(6)
    v_pk_fma_f32 v[104:105], v[164:165], v[178:179], v[232:233] op_sel:[0,1,0] op_sel_hi:[1,1,1]
    v_pk_fma_f32 v[106:107], v[166:167], v[178:179], v[234:235] op_sel:[0,1,0] op_sel_hi:[1,1,1]
    v_lshlrev_b32 v124, 16, v42
    v_and_b32 v125, s27, v42
    v_lshlrev_b32 v126, 16, v43
    v_and_b32 v127, s27, v43
    v_pk_fma_f32 v[108:109], v[168:169], v[176:177], v[124:125] op_sel:[0,1,0] op_sel_hi:[1,1,1]
    v_pk_fma_f32 v[110:111], v[170:171], v[176:177], v[126:127] op_sel:[0,1,0] op_sel_hi:[1,1,1]
    v_pk_fma_f32 v[112:113], v[168:169], v[178:179], v[124:125] op_sel:[0,1,0] op_sel_hi:[1,1,1]
    s_add_u32 m0, s59, 122880
    s_lshl_b32 s77, s63, 14
    s_add_u32 s77, s77, s90
    buffer_load_dwordx4 v21, s[44:47], s77 offen lds
    v_pk_fma_f32 v[114:115], v[170:171], v[178:179], v[126:127] op_sel:[0,1,0] op_sel_hi:[1,1,1]
    v_lshlrev_b32 v232, 16, v44
    v_and_b32 v233, s27, v44
    v_lshlrev_b32 v234, 16, v45
    v_and_b32 v235, s27, v45
    v_pk_fma_f32 v[116:117], v[172:173], v[176:177], v[232:233] op_sel:[0,1,0] op_sel_hi:[1,1,1]
    v_pk_fma_f32 v[118:119], v[174:175], v[176:177], v[234:235] op_sel:[0,1,0] op_sel_hi:[1,1,1]
    v_pk_fma_f32 v[120:121], v[172:173], v[178:179], v[232:233] op_sel:[0,1,0] op_sel_hi:[1,1,1]
    buffer_load_dwordx4 v228, s[44:47], s77 offen offset:1024 lds
    s_waitcnt vmcnt(12)
    ds_read_b64_tr_b16 a[208:209], v227 offset:8192
    v_pk_fma_f32 v[122:123], v[174:175], v[178:179], v[234:235] op_sel:[0,1,0] op_sel_hi:[1,1,1]
    .p2align 3
    v_pk_fma_f32 v[52:53], v[52:53], v[176:177], v[100:101] op_sel:[0,0,0] op_sel_hi:[1,0,1]
    v_pk_fma_f32 v[54:55], v[54:55], v[176:177], v[102:103] op_sel:[0,0,0] op_sel_hi:[1,0,1]
    v_pk_fma_f32 v[56:57], v[56:57], v[178:179], v[104:105] op_sel:[0,0,0] op_sel_hi:[1,0,1]
    v_pk_fma_f32 v[58:59], v[58:59], v[178:179], v[106:107] op_sel:[0,0,0] op_sel_hi:[1,0,1]
    v_pk_fma_f32 v[60:61], v[60:61], v[176:177], v[108:109] op_sel:[0,0,0] op_sel_hi:[1,0,1]
    v_pk_fma_f32 v[62:63], v[62:63], v[176:177], v[110:111] op_sel:[0,0,0] op_sel_hi:[1,0,1]
    v_pk_fma_f32 v[64:65], v[64:65], v[178:179], v[112:113] op_sel:[0,0,0] op_sel_hi:[1,0,1]
    s_add_u32 m0, s59, 106496
    s_lshl_b32 s77, s25, 14
    s_add_u32 s77, s77, s90
    buffer_load_dwordx4 v21, s[44:47], s77 offen lds
    v_pk_fma_f32 v[66:67], v[66:67], v[178:179], v[114:115] op_sel:[0,0,0] op_sel_hi:[1,0,1]
    v_pk_fma_f32 v[68:69], v[68:69], v[176:177], v[116:117] op_sel:[0,0,0] op_sel_hi:[1,0,1]
    v_pk_fma_f32 v[70:71], v[70:71], v[176:177], v[118:119] op_sel:[0,0,0] op_sel_hi:[1,0,1]
    v_pk_fma_f32 v[72:73], v[72:73], v[178:179], v[120:121] op_sel:[0,0,0] op_sel_hi:[1,0,1]
    v_pk_fma_f32 v[74:75], v[74:75], v[178:179], v[122:123] op_sel:[0,0,0] op_sel_hi:[1,0,1]
    .p2align 3
    v_pk_mul_f32 v[100:101], v[52:53], v[52:53]
    v_pk_mul_f32 v[102:103], v[54:55], v[54:55]
    v_pk_mul_f32 v[104:105], v[56:57], v[56:57]
    v_pk_mul_f32 v[106:107], v[58:59], v[58:59]
    v_pk_mul_f32 v[108:109], v[60:61], v[60:61]
    v_pk_mul_f32 v[110:111], v[62:63], v[62:63]
    v_pk_mul_f32 v[112:113], v[64:65], v[64:65]
    buffer_load_dwordx4 v228, s[44:47], s77 offen offset:1024 lds
    ds_read_b64_tr_b16 a[210:211], v227 offset:8704
    v_pk_mul_f32 v[114:115], v[66:67], v[66:67]
    v_pk_mul_f32 v[116:117], v[68:69], v[68:69]
    v_pk_mul_f32 v[118:119], v[70:71], v[70:71]
    v_pk_mul_f32 v[120:121], v[72:73], v[72:73]
    v_pk_mul_f32 v[122:123], v[74:75], v[74:75]
    .p2align 3
    v_pk_fma_f32 v[100:101], v[100:101], s[8:9], s[8:9] op_sel:[0,0,1] op_sel_hi:[1,0,1]
    v_pk_fma_f32 v[102:103], v[102:103], s[8:9], s[8:9] op_sel:[0,0,1] op_sel_hi:[1,0,1]
    v_pk_fma_f32 v[104:105], v[104:105], s[8:9], s[8:9] op_sel:[0,0,1] op_sel_hi:[1,0,1]
    v_pk_fma_f32 v[106:107], v[106:107], s[8:9], s[8:9] op_sel:[0,0,1] op_sel_hi:[1,0,1]
    v_pk_fma_f32 v[108:109], v[108:109], s[8:9], s[8:9] op_sel:[0,0,1] op_sel_hi:[1,0,1]
    v_pk_fma_f32 v[110:111], v[110:111], s[8:9], s[8:9] op_sel:[0,0,1] op_sel_hi:[1,0,1]
    v_pk_fma_f32 v[112:113], v[112:113], s[8:9], s[8:9] op_sel:[0,0,1] op_sel_hi:[1,0,1]
    ds_read_b64_tr_b16 a[212:213], v227 offset:8448
    ds_read_b64_tr_b16 a[214:215], v227 offset:8960
    v_pk_fma_f32 v[114:115], v[114:115], s[8:9], s[8:9] op_sel:[0,0,1] op_sel_hi:[1,0,1]
    v_pk_fma_f32 v[116:117], v[116:117], s[8:9], s[8:9] op_sel:[0,0,1] op_sel_hi:[1,0,1]
    v_pk_fma_f32 v[118:119], v[118:119], s[8:9], s[8:9] op_sel:[0,0,1] op_sel_hi:[1,0,1]
    v_pk_fma_f32 v[120:121], v[120:121], s[8:9], s[8:9] op_sel:[0,0,1] op_sel_hi:[1,0,1]
    v_pk_fma_f32 v[122:123], v[122:123], s[8:9], s[8:9] op_sel:[0,0,1] op_sel_hi:[1,0,1]
    .p2align 3
    v_pk_mul_f32 v[100:101], v[100:101], v[52:53]
    v_pk_mul_f32 v[102:103], v[102:103], v[54:55]
    v_pk_mul_f32 v[104:105], v[104:105], v[56:57]
    v_pk_mul_f32 v[106:107], v[106:107], v[58:59]
    v_pk_mul_f32 v[108:109], v[108:109], v[60:61]
    v_pk_mul_f32 v[110:111], v[110:111], v[62:63]
    v_pk_mul_f32 v[112:113], v[112:113], v[64:65]
    s_waitcnt vmcnt(12)
    ds_read_b64_tr_b16 a[216:217], v227 offset:16384
    ds_read_b64_tr_b16 a[218:219], v227 offset:16896
    v_pk_mul_f32 v[114:115], v[114:115], v[66:67]
    v_pk_mul_f32 v[116:117], v[116:117], v[68:69]
    v_pk_mul_f32 v[118:119], v[118:119], v[70:71]
    v_pk_mul_f32 v[120:121], v[120:121], v[72:73]
    v_pk_mul_f32 v[122:123], v[122:123], v[74:75]
    .p2align 3
    v_exp_f32 v100, v100
    v_exp_f32 v101, v101
    v_exp_f32 v102, v102
    v_exp_f32 v103, v103
    v_exp_f32 v104, v104
    v_exp_f32 v105, v105
    v_exp_f32 v106, v106
    ds_read_b64_tr_b16 a[220:221], v227 offset:16640
    ds_read_b64_tr_b16 a[222:223], v227 offset:17152
    v_exp_f32 v107, v107
    v_exp_f32 v108, v108
    v_exp_f32 v109, v109
    v_exp_f32 v110, v110
    v_exp_f32 v111, v111
    v_exp_f32 v112, v112
    v_exp_f32 v113, v113
    v_exp_f32 v114, v114
    s_waitcnt vmcnt(10)
    ds_read_b64_tr_b16 a[224:225], v226 offset:24576
    ds_read_b64_tr_b16 a[226:227], v226 offset:25088
    v_exp_f32 v115, v115
    v_exp_f32 v116, v116
    v_exp_f32 v117, v117
    v_exp_f32 v118, v118
    v_exp_f32 v119, v119
    v_exp_f32 v120, v120
    v_exp_f32 v121, v121
    v_exp_f32 v122, v122
    ds_read_b64_tr_b16 a[228:229], v226 offset:24832
    ds_read_b64_tr_b16 a[230:231], v226 offset:25344
    v_exp_f32 v123, v123
    .p2align 3
    v_pk_add_f32 v[100:101], v[100:101], 1.0 op_sel_hi:[1,0]
    v_pk_add_f32 v[102:103], v[102:103], 1.0 op_sel_hi:[1,0]
    v_pk_add_f32 v[104:105], v[104:105], 1.0 op_sel_hi:[1,0]
    v_pk_add_f32 v[106:107], v[106:107], 1.0 op_sel_hi:[1,0]
    v_pk_add_f32 v[108:109], v[108:109], 1.0 op_sel_hi:[1,0]
    v_pk_add_f32 v[110:111], v[110:111], 1.0 op_sel_hi:[1,0]
    v_pk_add_f32 v[112:113], v[112:113], 1.0 op_sel_hi:[1,0]
    s_waitcnt vmcnt(8)
    ds_read_b64_tr_b16 a[232:233], v226 offset:32768
    ds_read_b64_tr_b16 a[234:235], v226 offset:33280
    v_pk_add_f32 v[114:115], v[114:115], 1.0 op_sel_hi:[1,0]
    v_pk_add_f32 v[116:117], v[116:117], 1.0 op_sel_hi:[1,0]
    v_pk_add_f32 v[118:119], v[118:119], 1.0 op_sel_hi:[1,0]
    v_pk_add_f32 v[120:121], v[120:121], 1.0 op_sel_hi:[1,0]
    v_pk_add_f32 v[122:123], v[122:123], 1.0 op_sel_hi:[1,0]
    .p2align 3
    v_rcp_f32 v100, v100
    v_rcp_f32 v101, v101
    v_rcp_f32 v102, v102
    v_rcp_f32 v103, v103
    v_rcp_f32 v104, v104
    v_rcp_f32 v105, v105
    v_rcp_f32 v106, v106
    ds_read_b64_tr_b16 a[236:237], v226 offset:33024
    ds_read_b64_tr_b16 a[238:239], v226 offset:33536
    v_rcp_f32 v107, v107
    v_rcp_f32 v108, v108
    v_rcp_f32 v109, v109
    v_rcp_f32 v110, v110
    v_rcp_f32 v111, v111
    v_rcp_f32 v112, v112
    v_rcp_f32 v113, v113
    v_rcp_f32 v114, v114
    s_waitcnt vmcnt(6)
    ds_read_b64_tr_b16 a[240:241], v226 offset:0
    ds_read_b64_tr_b16 a[242:243], v226 offset:512
    v_rcp_f32 v115, v115
    v_rcp_f32 v116, v116
    v_rcp_f32 v117, v117
    v_rcp_f32 v118, v118
    v_rcp_f32 v119, v119
    v_rcp_f32 v120, v120
    v_rcp_f32 v121, v121
    v_rcp_f32 v122, v122
    ds_read_b64_tr_b16 a[244:245], v226 offset:256
    ds_read_b64_tr_b16 a[246:247], v226 offset:768
    v_rcp_f32 v123, v123
    .p2align 3
    v_pk_mul_f32 v[52:53], v[52:53], v[100:101]
    v_pk_mul_f32 v[54:55], v[54:55], v[102:103]
    v_pk_mul_f32 v[56:57], v[56:57], v[104:105]
    v_pk_mul_f32 v[58:59], v[58:59], v[106:107]
    v_pk_mul_f32 v[60:61], v[60:61], v[108:109]
    v_pk_mul_f32 v[62:63], v[62:63], v[110:111]
    v_pk_mul_f32 v[64:65], v[64:65], v[112:113]
    s_waitcnt vmcnt(4)
    ds_read_b64_tr_b16 a[248:249], v226 offset:16384
    ds_read_b64_tr_b16 a[250:251], v226 offset:16896
    v_pk_mul_f32 v[66:67], v[66:67], v[114:115]
    v_pk_mul_f32 v[68:69], v[68:69], v[116:117]
    v_pk_mul_f32 v[70:71], v[70:71], v[118:119]
    v_pk_mul_f32 v[72:73], v[72:73], v[120:121]
    v_pk_mul_f32 v[74:75], v[74:75], v[122:123]
    .p2align 3
    v_cvt_pk_bf16_f32 v136, v52, v53
    v_cvt_pk_bf16_f32 v137, v54, v55
    v_cvt_pk_bf16_f32 v138, v56, v57
    v_cvt_pk_bf16_f32 v139, v58, v59
    v_cvt_pk_bf16_f32 v140, v60, v61
    v_cvt_pk_bf16_f32 v141, v62, v63
    v_cvt_pk_bf16_f32 v142, v64, v65
    ds_read_b64_tr_b16 a[252:253], v226 offset:16640
    ds_read_b64_tr_b16 a[254:255], v226 offset:17152
    v_cvt_pk_bf16_f32 v143, v66, v67
    v_cvt_pk_bf16_f32 v144, v68, v69
    v_cvt_pk_bf16_f32 v145, v70, v71
    v_cvt_pk_bf16_f32 v146, v72, v73
    v_cvt_pk_bf16_f32 v147, v74, v75
    v_permlane16_swap_b32 v136, v138
    v_permlane16_swap_b32 v137, v139
    v_permlane16_swap_b32 v140, v142
    v_permlane16_swap_b32 v141, v143
    v_permlane16_swap_b32 v144, v146
    v_permlane16_swap_b32 v145, v147
    buffer_store_dwordx4 v[136:139], v17, s[52:55], s69 offen sc1
    buffer_store_dwordx4 v[140:143], v17, s[52:55], s71 offen sc1
    buffer_store_dwordx4 v[144:147], v17, s[52:55], s98 offen sc1
    s_getpc_b64 s[22:23]
L_ca20:
    v_min_u32 v237, L_code_end-L_ca20-128, v239
    global_load_dword v254, v237, s[22:23]
    s_barrier
    ds_read_b128 v[116:119], v8 offset:28672
    ds_read_b128 v[120:123], v9 offset:28672
    s_waitcnt lgkmcnt(1)
    v_mfma_f32_16x16x32_bf16 v[76:79], a[28:31], v[116:119], v[76:79]
    s_add_u32 m0, s59, 131072
    ds_read_b128 v[100:103], v8 offset:32768
    s_lshl_b32 s77, s25, 14
    v_mfma_f32_16x16x32_bf16 v[84:87], a[92:95], v[116:119], v[84:87]
    s_add_u32 s77, s77, s90
    ds_read_b128 v[104:107], v9 offset:32768
    s_add_u32 s77, s77, 65536
    v_mfma_f32_16x16x32_bf16 v[92:95], a[156:159], v[116:119], v[92:95]
    s_waitcnt lgkmcnt(2)
    buffer_load_dwordx4 v21, s[44:47], s77 offen lds
    buffer_load_dwordx4 v228, s[44:47], s77 offen offset:1024 lds
    v_mfma_f32_16x16x32_bf16 v[80:83], a[28:31], v[120:123], v[80:83]
    s_add_u32 m0, s59, 139264
    s_lshl_b32 s77, s68, 14
    s_add_u32 s77, s77, s90
    v_mfma_f32_16x16x32_bf16 v[88:91], a[92:95], v[120:123], v[88:91]
    buffer_load_dwordx4 v21, s[44:47], s77 offen lds
    buffer_load_dwordx4 v228, s[44:47], s77 offen offset:1024 lds
    v_mfma_f32_16x16x32_bf16 v[96:99], a[156:159], v[120:123], v[96:99]
    s_waitcnt lgkmcnt(1)
    v_mfma_f32_16x16x32_bf16 v[76:79], a[32:35], v[100:103], v[76:79]
    ds_read_b128 v[116:119], v8 offset:36864
    v_mfma_f32_16x16x32_bf16 v[84:87], a[96:99], v[100:103], v[84:87]
    s_add_u32 m0, s59, 147456
    ds_read_b128 v[120:123], v9 offset:36864
    s_lshl_b32 s77, s56, 14
    v_mfma_f32_16x16x32_bf16 v[92:95], a[160:163], v[100:103], v[92:95]
    s_waitcnt lgkmcnt(2)
    s_add_u32 s77, s77, s90
    buffer_load_dwordx4 v21, s[44:47], s77 offen lds
    v_mfma_f32_16x16x32_bf16 v[80:83], a[32:35], v[104:107], v[80:83]
    buffer_load_dwordx4 v228, s[44:47], s77 offen offset:1024 lds
    v_mfma_f32_16x16x32_bf16 v[88:91], a[96:99], v[104:107], v[88:91]
    v_mfma_f32_16x16x32_bf16 v[96:99], a[160:163], v[104:107], v[96:99]
    s_waitcnt lgkmcnt(1)
    v_mfma_f32_16x16x32_bf16 v[76:79], a[36:39], v[116:119], v[76:79]
    ds_read_b128 v[100:103], v8 offset:40960
    v_mfma_f32_16x16x32_bf16 v[84:87], a[100:103], v[116:119], v[84:87]
    ds_read_b128 v[104:107], v9 offset:40960
    v_mfma_f32_16x16x32_bf16 v[92:95], a[164:167], v[116:119], v[92:95]
    s_waitcnt lgkmcnt(2)
    s_add_u32 m0, s59, 90112
    s_lshl_b32 s77, s56, 14
    v_mfma_f32_16x16x32_bf16 v[80:83], a[36:39], v[120:123], v[80:83]
    s_add_u32 s77, s77, s90
    s_add_u32 s77, s77, 65536
    buffer_load_dwordx4 v21, s[44:47], s77 offen lds
    v_mfma_f32_16x16x32_bf16 v[88:91], a[100:103], v[120:123], v[88:91]
    buffer_load_dwordx4 v228, s[44:47], s77 offen offset:1024 lds
    v_mfma_f32_16x16x32_bf16 v[96:99], a[164:167], v[120:123], v[96:99]
    s_waitcnt lgkmcnt(1)
    v_mfma_f32_16x16x32_bf16 v[76:79], a[40:43], v[100:103], v[76:79]
    ds_read_b128 v[116:119], v8 offset:45056
    v_mfma_f32_16x16x32_bf16 v[84:87], a[104:107], v[100:103], v[84:87]
    ds_read_b128 v[120:123], v9 offset:45056
    v_mfma_f32_16x16x32_bf16 v[92:95], a[168:171], v[100:103], v[92:95]
    s_waitcnt lgkmcnt(2)
    v_mfma_f32_16x16x32_bf16 v[80:83], a[40:43], v[104:107], v[80:83]
    v_mfma_f32_16x16x32_bf16 v[88:91], a[104:107], v[104:107], v[88:91]
    s_add_u32 m0, s59, 98304
    s_lshl_b32 s77, s18, 14
    s_add_u32 s77, s77, s90
    v_mfma_f32_16x16x32_bf16 v[96:99], a[168:171], v[104:107], v[96:99]
    s_waitcnt lgkmcnt(1)
    buffer_load_dwordx4 v21, s[44:47], s77 offen lds
    buffer_load_dwordx4 v228, s[44:47], s77 offen offset:1024 lds
    v_mfma_f32_16x16x32_bf16 v[76:79], a[44:47], v[116:119], v[76:79]
    ds_read_b128 v[100:103], v8 offset:49152
    v_mfma_f32_16x16x32_bf16 v[84:87], a[108:111], v[116:119], v[84:87]
    ds_read_b128 v[104:107], v9 offset:49152
    v_mfma_f32_16x16x32_bf16 v[92:95], a[172:175], v[116:119], v[92:95]
    s_waitcnt lgkmcnt(2)
    v_mfma_f32_16x16x32_bf16 v[80:83], a[44:47], v[120:123], v[80:83]
    v_mfma_f32_16x16x32_bf16 v[88:91], a[108:111], v[120:123], v[88:91]
    v_mfma_f32_16x16x32_bf16 v[96:99], a[172:175], v[120:123], v[96:99]
    s_waitcnt lgkmcnt(1)
    v_mfma_f32_16x16x32_bf16 v[76:79], a[48:51], v[100:103], v[76:79]
    ds_read_b128 v[116:119], v8 offset:53248
    v_mfma_f32_16x16x32_bf16 v[84:87], a[112:115], v[100:103], v[84:87]
    ds_read_b128 v[120:123], v9 offset:53248
    v_mfma_f32_16x16x32_bf16 v[92:95], a[176:179], v[100:103], v[92:95]
    s_waitcnt lgkmcnt(2)
    v_mfma_f32_16x16x32_bf16 v[80:83], a[48:51], v[104:107], v[80:83]
    v_mfma_f32_16x16x32_bf16 v[88:91], a[112:115], v[104:107], v[88:91]
    v_mfma_f32_16x16x32_bf16 v[96:99], a[176:179], v[104:107], v[96:99]
    s_waitcnt lgkmcnt(1)
    v_mfma_f32_16x16x32_bf16 v[76:79], a[52:55], v[116:119], v[76:79]
    ds_read_b128 v[100:103], v8 offset:57344
    v_mfma_f32_16x16x32_bf16 v[84:87], a[116:119], v[116:119], v[84:87]
    ds_read_b128 v[104:107], v9 offset:57344
    v_mfma_f32_16x16x32_bf16 v[92:95], a[180:183], v[116:119], v[92:95]
    s_waitcnt lgkmcnt(2)
    ds_read_b128 v[32:35], v217
    v_mfma_f32_16x16x32_bf16 v[80:83], a[52:55], v[120:123], v[80:83]
    ds_read_b128 v[36:39], v217 offset:2048
    v_mfma_f32_16x16x32_bf16 v[88:91], a[116:119], v[120:123], v[88:91]
    v_mfma_f32_16x16x32_bf16 v[96:99], a[180:183], v[120:123], v[96:99]
    s_waitcnt lgkmcnt(3)
    v_mfma_f32_16x16x32_bf16 v[76:79], a[56:59], v[100:103], v[76:79]
    ds_read_b128 v[116:119], v8 offset:61440
    v_mfma_f32_16x16x32_bf16 v[84:87], a[120:123], v[100:103], v[84:87]
    ds_read_b128 v[120:123], v9 offset:61440
    v_mfma_f32_16x16x32_bf16 v[92:95], a[184:187], v[100:103], v[92:95]
    s_waitcnt lgkmcnt(4)
    v_mfma_f32_16x16x32_bf16 v[80:83], a[56:59], v[104:107], v[80:83]
    v_mfma_f32_16x16x32_bf16 v[88:91], a[120:123], v[104:107], v[88:91]
    v_mfma_f32_16x16x32_bf16 v[96:99], a[184:187], v[104:107], v[96:99]
    s_waitcnt lgkmcnt(1)
    s_add_u32 m0, s59, 65536
    s_lshl_b32 s77, s57, 14
    v_mfma_f32_16x16x32_bf16 v[76:79], a[60:63], v[116:119], v[76:79]
    s_add_u32 s77, s77, s90
    buffer_load_dwordx4 v21, s[44:47], s77 offen lds
    buffer_load_dwordx4 v228, s[44:47], s77 offen offset:1024 lds
    v_mfma_f32_16x16x32_bf16 v[84:87], a[124:127], v[116:119], v[84:87]
    v_mfma_f32_16x16x32_bf16 v[92:95], a[188:191], v[116:119], v[92:95]
    s_waitcnt lgkmcnt(0)
    v_mfma_f32_16x16x32_bf16 v[80:83], a[60:63], v[120:123], v[80:83]
    v_mfma_f32_16x16x32_bf16 v[88:91], a[124:127], v[120:123], v[88:91]
    v_mfma_f32_16x16x32_bf16 v[96:99], a[188:191], v[120:123], v[96:99]
    s_barrier
    .p2align 3
    v_lshlrev_b32 v232, 16, v40
    v_and_b32 v233, s27, v40
    v_lshlrev_b32 v234, 16, v41
    v_and_b32 v235, s27, v41
    v_pk_fma_f32 v[100:101], v[164:165], v[180:181], v[232:233] op_sel:[0,1,0] op_sel_hi:[1,1,1]
    v_pk_fma_f32 v[102:103], v[166:167], v[180:181], v[234:235] op_sel:[0,1,0] op_sel_hi:[1,1,1]
    v_pk_fma_f32 v[104:105], v[164:165], v[182:183], v[232:233] op_sel:[0,1,0] op_sel_hi:[1,1,1]
    s_add_u32 m0, s60, 0
    s_lshl_b32 s77, s57, 14
    s_add_u32 s77, s77, s90
    s_add_u32 s77, s77, 65536
    buffer_load_dwordx4 v21, s[44:47], s77 offen lds
    v_pk_fma_f32 v[106:107], v[166:167], v[182:183], v[234:235] op_sel:[0,1,0] op_sel_hi:[1,1,1]
    v_lshlrev_b32 v124, 16, v42
    v_and_b32 v125, s27, v42
    v_lshlrev_b32 v126, 16, v43
    v_and_b32 v127, s27, v43
    v_pk_fma_f32 v[108:109], v[168:169], v[180:181], v[124:125] op_sel:[0,1,0] op_sel_hi:[1,1,1]
    v_pk_fma_f32 v[110:111], v[170:171], v[180:181], v[126:127] op_sel:[0,1,0] op_sel_hi:[1,1,1]
    v_pk_fma_f32 v[112:113], v[168:169], v[182:183], v[124:125] op_sel:[0,1,0] op_sel_hi:[1,1,1]
    buffer_load_dwordx4 v228, s[44:47], s77 offen offset:1024 lds
    v_pk_fma_f32 v[114:115], v[170:171], v[182:183], v[126:127] op_sel:[0,1,0] op_sel_hi:[1,1,1]
    v_lshlrev_b32 v232, 16, v44
    v_and_b32 v233, s27, v44
    v_lshlrev_b32 v234, 16, v45
    v_and_b32 v235, s27, v45
    v_pk_fma_f32 v[116:117], v[172:173], v[180:181], v[232:233] op_sel:[0,1,0] op_sel_hi:[1,1,1]
    v_pk_fma_f32 v[118:119], v[174:175], v[180:181], v[234:235] op_sel:[0,1,0] op_sel_hi:[1,1,1]
    v_pk_fma_f32 v[120:121], v[172:173], v[182:183], v[232:233] op_sel:[0,1,0] op_sel_hi:[1,1,1]
    s_add_u32 m0, s60, 2048
    s_lshl_b32 s77, s19, 14
    s_add_u32 s77, s77, s90
    buffer_load_dwordx4 v21, s[44:47], s77 offen lds
    v_pk_fma_f32 v[122:123], v[174:175], v[182:183], v[234:235] op_sel:[0,1,0] op_sel_hi:[1,1,1]
    s_waitcnt vmcnt(16)
    buffer_load_dwordx4 v228, s[44:47], s77 offen offset:1024 lds
    s_cmp_lg_u32 s10, 0
    s_cbranch_scc1 L_sl21
    buffer_store_dword v12, v251, s[52:55], s11 offen offset:384 sc1
    s_branch L_sd22
L_sl21:
    buffer_store_dword v12, v251, s[52:55], s11 offen offset:384
L_sd22:
    .p2align 3
    v_pk_fma_f32 v[76:77], v[76:77], v[180:181], v[100:101] op_sel:[0,0,0] op_sel_hi:[1,0,1]
    v_pk_fma_f32 v[78:79], v[78:79], v[180:181], v[102:103] op_sel:[0,0,0] op_sel_hi:[1,0,1]
    v_pk_fma_f32 v[80:81], v[80:81], v[182:183], v[104:105] op_sel:[0,0,0] op_sel_hi:[1,0,1]
    v_pk_fma_f32 v[82:83], v[82:83], v[182:183], v[106:107] op_sel:[0,0,0] op_sel_hi:[1,0,1]
    v_pk_fma_f32 v[84:85], v[84:85], v[180:181], v[108:109] op_sel:[0,0,0] op_sel_hi:[1,0,1]
    v_pk_fma_f32 v[86:87], v[86:87], v[180:181], v[110:111] op_sel:[0,0,0] op_sel_hi:[1,0,1]
    v_pk_fma_f32 v[88:89], v[88:89], v[182:183], v[112:113] op_sel:[0,0,0] op_sel_hi:[1,0,1]
    s_add_u32 m0, s60, 4096
    s_lshl_b32 s77, s58, 14
    s_add_u32 s77, s77, s90
    buffer_load_dwordx4 v21, s[44:47], s77 offen lds
    v_pk_fma_f32 v[90:91], v[90:91], v[182:183], v[114:115] op_sel:[0,0,0] op_sel_hi:[1,0,1]
    v_pk_fma_f32 v[92:93], v[92:93], v[180:181], v[116:117] op_sel:[0,0,0] op_sel_hi:[1,0,1]
    v_pk_fma_f32 v[94:95], v[94:95], v[180:181], v[118:119] op_sel:[0,0,0] op_sel_hi:[1,0,1]
    v_pk_fma_f32 v[96:97], v[96:97], v[182:183], v[120:121] op_sel:[0,0,0] op_sel_hi:[1,0,1]
    v_pk_fma_f32 v[98:99], v[98:99], v[182:183], v[122:123] op_sel:[0,0,0] op_sel_hi:[1,0,1]
    .p2align 3
    v_pk_mul_f32 v[100:101], v[76:77], v[76:77]
    v_pk_mul_f32 v[102:103], v[78:79], v[78:79]
    v_pk_mul_f32 v[104:105], v[80:81], v[80:81]
    v_pk_mul_f32 v[106:107], v[82:83], v[82:83]
    v_pk_mul_f32 v[108:109], v[84:85], v[84:85]
    v_pk_mul_f32 v[110:111], v[86:87], v[86:87]
    v_pk_mul_f32 v[112:113], v[88:89], v[88:89]
    buffer_load_dwordx4 v228, s[44:47], s77 offen offset:1024 lds
    ds_read_b64_tr_b16 a[0:1], v226 offset:57344
    v_pk_mul_f32 v[114:115], v[90:91], v[90:91]
    v_pk_mul_f32 v[116:117], v[92:93], v[92:93]
    v_pk_mul_f32 v[118:119], v[94:95], v[94:95]
    v_pk_mul_f32 v[120:121], v[96:97], v[96:97]
    v_pk_mul_f32 v[122:123], v[98:99], v[98:99]
    .p2align 3
    v_pk_fma_f32 v[100:101], v[100:101], s[8:9], s[8:9] op_sel:[0,0,1] op_sel_hi:[1,0,1]
    v_pk_fma_f32 v[102:103], v[102:103], s[8:9], s[8:9] op_sel:[0,0,1] op_sel_hi:[1,0,1]
    v_pk_fma_f32 v[104:105], v[104:105], s[8:9], s[8:9] op_sel:[0,0,1] op_sel_hi:[1,0,1]
    v_pk_fma_f32 v[106:107], v[106:107], s[8:9], s[8:9] op_sel:[0,0,1] op_sel_hi:[1,0,1]
    v_pk_fma_f32 v[108:109], v[108:109], s[8:9], s[8:9] op_sel:[0,0,1] op_sel_hi:[1,0,1]
    v_pk_fma_f32 v[110:111], v[110:111], s[8:9], s[8:9] op_sel:[0,0,1] op_sel_hi:[1,0,1]
    v_pk_fma_f32 v[112:113], v[112:113], s[8:9], s[8:9] op_sel:[0,0,1] op_sel_hi:[1,0,1]
    ds_read_b64_tr_b16 a[2:3], v226 offset:57856
    v_pk_fma_f32 v[114:115], v[114:115], s[8:9], s[8:9] op_sel:[0,0,1] op_sel_hi:[1,0,1]
    v_pk_fma_f32 v[116:117], v[116:117], s[8:9], s[8:9] op_sel:[0,0,1] op_sel_hi:[1,0,1]
    v_pk_fma_f32 v[118:119], v[118:119], s[8:9], s[8:9] op_sel:[0,0,1] op_sel_hi:[1,0,1]
    v_pk_fma_f32 v[120:121], v[120:121], s[8:9], s[8:9] op_sel:[0,0,1] op_sel_hi:[1,0,1]
    v_pk_fma_f32 v[122:123], v[122:123], s[8:9], s[8:9] op_sel:[0,0,1] op_sel_hi:[1,0,1]
    .p2align 3
    v_pk_mul_f32 v[100:101], v[100:101], v[76:77]
    v_pk_mul_f32 v[102:103], v[102:103], v[78:79]
    v_pk_mul_f32 v[104:105], v[104:105], v[80:81]
    v_pk_mul_f32 v[106:107], v[106:107], v[82:83]
    v_pk_mul_f32 v[108:109], v[108:109], v[84:85]
    v_pk_mul_f32 v[110:111], v[110:111], v[86:87]
    v_pk_mul_f32 v[112:113], v[112:113], v[88:89]
    ds_read_b64_tr_b16 a[4:5], v226 offset:57600
    v_pk_mul_f32 v[114:115], v[114:115], v[90:91]
    v_pk_mul_f32 v[116:117], v[116:117], v[92:93]
    v_pk_mul_f32 v[118:119], v[118:119], v[94:95]
    v_pk_mul_f32 v[120:121], v[120:121], v[96:97]
    v_pk_mul_f32 v[122:123], v[122:123], v[98:99]
    .p2align 3
    v_exp_f32 v100, v100
    v_exp_f32 v101, v101
    v_exp_f32 v102, v102
    v_exp_f32 v103, v103
    v_exp_f32 v104, v104
    v_exp_f32 v105, v105
    v_exp_f32 v106, v106
    s_add_u32 m0, s60, 6144
    s_lshl_b32 s77, s58, 14
    s_add_u32 s77, s77, s90
    s_add_u32 s77, s77, 65536
    buffer_load_dwordx4 v21, s[44:47], s77 offen lds
    v_exp_f32 v107, v107
    v_exp_f32 v108, v108
    v_exp_f32 v109, v109
    v_exp_f32 v110, v110
    v_exp_f32 v111, v111
    v_exp_f32 v112, v112
    v_exp_f32 v113, v113
    v_exp_f32 v114, v114
    buffer_load_dwordx4 v228, s[44:47], s77 offen offset:1024 lds
    v_exp_f32 v115, v115
    v_exp_f32 v116, v116
    v_exp_f32 v117, v117
    v_exp_f32 v118, v118
    v_exp_f32 v119, v119
    v_exp_f32 v120, v120
    v_exp_f32 v121, v121
    v_exp_f32 v122, v122
    s_add_u32 m0, s60, 8192
    s_lshl_b32 s77, s20, 14
    s_add_u32 s77, s77, s90
    buffer_load_dwordx4 v21, s[44:47], s77 offen lds
    v_exp_f32 v123, v123
    .p2align 3
    v_pk_add_f32 v[100:101], v[100:101], 1.0 op_sel_hi:[1,0]
    v_pk_add_f32 v[102:103], v[102:103], 1.0 op_sel_hi:[1,0]
    v_pk_add_f32 v[104:105], v[104:105], 1.0 op_sel_hi:[1,0]
    v_pk_add_f32 v[106:107], v[106:107], 1.0 op_sel_hi:[1,0]
    v_pk_add_f32 v[108:109], v[108:109], 1.0 op_sel_hi:[1,0]
    v_pk_add_f32 v[110:111], v[110:111], 1.0 op_sel_hi:[1,0]
    v_pk_add_f32 v[112:113], v[112:113], 1.0 op_sel_hi:[1,0]
    buffer_load_dwordx4 v228, s[44:47], s77 offen offset:1024 lds
    v_pk_add_f32 v[114:115], v[114:115], 1.0 op_sel_hi:[1,0]
    v_pk_add_f32 v[116:117], v[116:117], 1.0 op_sel_hi:[1,0]
    v_pk_add_f32 v[118:119], v[118:119], 1.0 op_sel_hi:[1,0]
    v_pk_add_f32 v[120:121], v[120:121], 1.0 op_sel_hi:[1,0]
    v_pk_add_f32 v[122:123], v[122:123], 1.0 op_sel_hi:[1,0]
    .p2align 3
    v_rcp_f32 v100, v100
    v_rcp_f32 v101, v101
    v_rcp_f32 v102, v102
    v_rcp_f32 v103, v103
    v_rcp_f32 v104, v104
    v_rcp_f32 v105, v105
    v_rcp_f32 v106, v106
    s_add_u32 m0, s60, 10240
    s_lshl_b32 s77, s100, 14
    s_add_u32 s77, s77, s90
    buffer_load_dwordx4 v21, s[44:47], s77 offen lds
    v_rcp_f32 v107, v107
    v_rcp_f32 v108, v108
    v_rcp_f32 v109, v109
    v_rcp_f32 v110, v110
    v_rcp_f32 v111, v111
    v_rcp_f32 v112, v112
    v_rcp_f32 v113, v113
    v_rcp_f32 v114, v114
    buffer_load_dwordx4 v228, s[44:47], s77 offen offset:1024 lds
    v_rcp_f32 v115, v115
    v_rcp_f32 v116, v116
    v_rcp_f32 v117, v117
    v_rcp_f32 v118, v118
    v_rcp_f32 v119, v119
    v_rcp_f32 v120, v120
    v_rcp_f32 v121, v121
    v_rcp_f32 v122, v122
    s_add_u32 m0, s60, 12288
    s_lshl_b32 s77, s100, 14
    s_add_u32 s77, s77, s90
    s_add_u32 s77, s77, 65536
    buffer_load_dwordx4 v21, s[44:47], s77 offen lds
    v_rcp_f32 v123, v123
    .p2align 3
    v_pk_mul_f32 v[76:77], v[76:77], v[100:101]
    v_pk_mul_f32 v[78:79], v[78:79], v[102:103]
    v_pk_mul_f32 v[80:81], v[80:81], v[104:105]
    v_pk_mul_f32 v[82:83], v[82:83], v[106:107]
    v_pk_mul_f32 v[84:85], v[84:85], v[108:109]
    v_pk_mul_f32 v[86:87], v[86:87], v[110:111]
    v_pk_mul_f32 v[88:89], v[88:89], v[112:113]
    buffer_load_dwordx4 v228, s[44:47], s77 offen offset:1024 lds
    ds_read_b64_tr_b16 a[6:7], v226 offset:58112
    v_pk_mul_f32 v[90:91], v[90:91], v[114:115]
    v_pk_mul_f32 v[92:93], v[92:93], v[116:117]
    v_pk_mul_f32 v[94:95], v[94:95], v[118:119]
    v_pk_mul_f32 v[96:97], v[96:97], v[120:121]
    v_pk_mul_f32 v[98:99], v[98:99], v[122:123]
    buffer_load_dword v236, v231, s[52:55], s11 offen offset:384 sc1
    .p2align 3
    v_cvt_pk_bf16_f32 v212, v76, v77
    v_cvt_pk_bf16_f32 v213, v78, v79
    v_cvt_pk_bf16_f32 v214, v80, v81
    v_cvt_pk_bf16_f32 v215, v82, v83
    v_cvt_pk_bf16_f32 v216, v84, v85
    v_cvt_pk_bf16_f32 v217, v86, v87
    v_cvt_pk_bf16_f32 v218, v88, v89
    ds_read_b64_tr_b16 a[8:9], v226 offset:40960
    v_cvt_pk_bf16_f32 v219, v90, v91
    v_cvt_pk_bf16_f32 v220, v92, v93
    v_cvt_pk_bf16_f32 v221, v94, v95
    v_cvt_pk_bf16_f32 v222, v96, v97
    v_cvt_pk_bf16_f32 v223, v98, v99
    v_permlane16_swap_b32 v212, v214
    v_permlane16_swap_b32 v213, v215
    v_permlane16_swap_b32 v216, v218
    v_permlane16_swap_b32 v217, v219
    v_permlane16_swap_b32 v220, v222
    v_permlane16_swap_b32 v221, v223
    buffer_store_dwordx4 v[212:215], v17, s[52:55], s70 offen sc1
    buffer_store_dwordx4 v[216:219], v17, s[52:55], s97 offen sc1
    buffer_store_dwordx4 v[220:223], v17, s[52:55], s99 offen sc1
    s_waitcnt vmcnt(3)
    v_cmp_ne_u32 vcc, 1, v236
    s_nop 0
    s_cbranch_vccz L_cf23_x
L_cf23:
    buffer_load_dword v236, v231, s[52:55], s11 offen offset:384 sc1
    s_waitcnt vmcnt(0)
    v_cmp_ne_u32 vcc, 1, v236
    s_nop 0
    s_cbranch_vccz L_cf23_x
    s_add_u32 s79, s79, 1
    s_cmp_lt_u32 s79, 0x200000
    s_cbranch_scc1 L_cf23
L_cf23_x:
    s_lshl_b32 s78, s1, 10
    s_add_u32 s78, s78, s24
    buffer_load_dwordx4 v[148:151], v17, s[52:55], s78 offen sc1
    s_lshl_b32 s78, s1, 10
    s_add_u32 s78, s78, s24
    s_add_u32 s78, s78, 4096
    buffer_load_dwordx4 v[152:155], v17, s[52:55], s78 offen sc1
    s_lshl_b32 s78, s62, 10
    s_add_u32 s78, s78, s24
    buffer_load_dwordx4 v[156:159], v17, s[52:55], s78 offen sc1
    s_lshl_b32 s78, s13, 10
    s_add_u32 s78, s78, s24
    buffer_load_dwordx4 v[160:163], v17, s[52:55], s78 offen sc1
    s_lshl_b32 s78, s13, 10
    s_add_u32 s78, s78, s24
    s_add_u32 s78, s78, 4096
    buffer_load_dwordx4 v[164:167], v17, s[52:55], s78 offen sc1
    s_lshl_b32 s78, s63, 10
    s_add_u32 s78, s78, s24
    buffer_load_dwordx4 v[168:171], v17, s[52:55], s78 offen sc1
    s_lshl_b32 s78, s25, 10
    s_add_u32 s78, s78, s24
    buffer_load_dwordx4 v[172:175], v17, s[52:55], s78 offen sc1
    s_lshl_b32 s78, s25, 10
    s_add_u32 s78, s78, s24
    s_add_u32 s78, s78, 4096
    buffer_load_dwordx4 v[176:179], v17, s[52:55], s78 offen sc1
    s_lshl_b32 s78, s68, 10
    s_add_u32 s78, s78, s24
T6:
    s_cbranch_execz L_tret
    buffer_load_dwordx4 v[180:183], v17, s[52:55], s78 offen sc1
    s_lshl_b32 s78, s56, 10
    s_add_u32 s78, s78, s24
    buffer_load_dwordx4 v[184:187], v17, s[52:55], s78 offen sc1
    s_lshl_b32 s78, s56, 10
    s_add_u32 s78, s78, s24
    s_add_u32 s78, s78, 4096
    buffer_load_dwordx4 v[188:191], v17, s[52:55], s78 offen sc1
    v_mfma_f32_32x32x16_bf16 v[52:67], a[192:195], v[136:139], 0
    s_lshl_b32 s78, s18, 10
    s_add_u32 s78, s78, s24
    buffer_load_dwordx4 v[192:195], v17, s[52:55], s78 offen sc1
    v_lshlrev_b32 v24, 16, v46
    v_and_b32 v25, s27, v46
    v_lshlrev_b32 v26, 16, v47
    v_and_b32 v27, s27, v47
    v_mfma_f32_32x32x16_bf16 v[68:83], a[196:199], v[136:139], 0
    v_lshlrev_b32 v28, 16, v48
    v_and_b32 v29, s27, v48
    v_lshlrev_b32 v30, 16, v49
    v_and_b32 v31, s27, v49
    v_lshlrev_b32 v40, 16, v32
    v_and_b32 v41, s27, v32
    v_mfma_f32_32x32x16_bf16 v[52:67], a[200:203], v[140:143], v[52:67]
    s_lshl_b32 s78, s57, 10
    s_add_u32 s78, s78, s24
    buffer_load_dwordx4 v[196:199], v17, s[52:55], s78 offen sc1
    v_lshlrev_b32 v42, 16, v33
    v_and_b32 v43, s27, v33
    v_lshlrev_b32 v44, 16, v34
    v_and_b32 v45, s27, v34
    v_mfma_f32_32x32x16_bf16 v[68:83], a[204:207], v[140:143], v[68:83]
    v_lshlrev_b32 v46, 16, v35
    v_and_b32 v47, s27, v35
    v_add_f32 v40, v40, v24
    v_add_f32 v41, v41, v25
    v_add_f32 v42, v42, v26
    v_add_f32 v43, v43, v27
    s_waitcnt vmcnt(13)
    s_cmp_lg_u32 s10, 0
    s_cbranch_scc1 L_sl24
    buffer_store_dword v12, v251, s[52:55], s11 offen offset:512 sc1
    s_branch L_sd25
L_sl24:
    buffer_store_dword v12, v251, s[52:55], s11 offen offset:512
L_sd25:
    v_mfma_f32_32x32x16_bf16 v[52:67], a[208:211], v[144:147], v[52:67]
    s_lshl_b32 s78, s57, 10
    s_add_u32 s78, s78, s24
    s_add_u32 s78, s78, 4096
    buffer_load_dwordx4 v[200:203], v17, s[52:55], s78 offen sc1
    v_add_f32 v44, v44, v28
    v_add_f32 v45, v45, v29
    v_add_f32 v46, v46, v30
    v_mfma_f32_32x32x16_bf16 v[68:83], a[212:215], v[144:147], v[68:83]
    v_add_f32 v47, v47, v31
    v_lshlrev_b32 v116, 16, v36
    v_and_b32 v117, s27, v36
    v_lshlrev_b32 v118, 16, v37
    v_and_b32 v119, s27, v37
    v_lshlrev_b32 v120, 16, v38
    s_waitcnt vmcnt(14)
    v_mfma_f32_32x32x16_bf16 v[52:67], a[216:219], v[148:151], v[52:67]
    s_lshl_b32 s78, s19, 10
    s_add_u32 s78, s78, s24
    buffer_load_dwordx4 v[204:207], v17, s[52:55], s78 offen sc1
    v_and_b32 v121, s27, v38
    v_lshlrev_b32 v122, 16, v39
    v_and_b32 v123, s27, v39
    v_add_f32 v116, v116, v24
    v_mfma_f32_32x32x16_bf16 v[68:83], a[220:223], v[148:151], v[68:83]
    v_add_f32 v117, v117, v25
    v_add_f32 v118, v118, v26
    v_add_f32 v119, v119, v27
    v_add_f32 v120, v120, v28
    v_add_f32 v121, v121, v29
    v_add_f32 v122, v122, v30
    s_waitcnt vmcnt(14)
    v_mfma_f32_32x32x16_bf16 v[52:67], a[224:227], v[152:155], v[52:67]
    s_lshl_b32 s78, s58, 10
    s_add_u32 s78, s78, s24
    buffer_load_dwordx4 v[208:211], v17, s[52:55], s78 offen sc1
    v_add_f32 v123, v123, v31
    ds_read_b64_tr_b16 a[10:11], v226 offset:41472
    ds_read_b64_tr_b16 a[12:13], v226 offset:41216
    v_mfma_f32_32x32x16_bf16 v[68:83], a[228:231], v[152:155], v[68:83]
    ds_read_b64_tr_b16 a[14:15], v226 offset:41728
    ds_read_b64_tr_b16 a[16:17], v227 offset:0
    s_waitcnt vmcnt(14)
    v_mfma_f32_32x32x16_bf16 v[52:67], a[232:235], v[156:159], v[52:67]
    s_lshl_b32 s78, s58, 10
    s_add_u32 s78, s78, s24
    s_add_u32 s78, s78, 4096
    buffer_load_dwordx4 v[148:151], v17, s[52:55], s78 offen sc1
    ds_read_b64_tr_b16 a[18:19], v227 offset:512
    ds_read_b64_tr_b16 a[20:21], v227 offset:256
    v_mfma_f32_32x32x16_bf16 v[68:83], a[236:239], v[156:159], v[68:83]
    ds_read_b64_tr_b16 a[22:23], v227 offset:768
    ds_read_b64_tr_b16 a[24:25], v227 offset:8192
    s_waitcnt vmcnt(14)
    v_mfma_f32_32x32x16_bf16 v[52:67], a[240:243], v[160:163], v[52:67]
    s_lshl_b32 s78, s20, 10
    s_add_u32 s78, s78, s24
    buffer_load_dwordx4 v[152:155], v17, s[52:55], s78 offen sc1
    ds_read_b64_tr_b16 a[26:27], v227 offset:8704
    ds_read_b64_tr_b16 a[28:29], v227 offset:8448
    v_mfma_f32_32x32x16_bf16 v[68:83], a[244:247], v[160:163], v[68:83]
    ds_read_b64_tr_b16 a[30:31], v227 offset:8960
    ds_read_b64_tr_b16 a[32:33], v227 offset:16384
    s_waitcnt vmcnt(14)
    v_mfma_f32_32x32x16_bf16 v[52:67], a[248:251], v[164:167], v[52:67]
    s_lshl_b32 s78, s100, 10
    s_add_u32 s78, s78, s24
    buffer_load_dwordx4 v[156:159], v17, s[52:55], s78 offen sc1
    ds_read_b64_tr_b16 a[34:35], v227 offset:16896
    ds_read_b64_tr_b16 a[36:37], v227 offset:16640
    v_mfma_f32_32x32x16_bf16 v[68:83], a[252:255], v[164:167], v[68:83]
    ds_read_b64_tr_b16 a[38:39], v227 offset:17152
    ds_read_b64_tr_b16 a[40:41], v226 offset:24576
    s_waitcnt vmcnt(14) lgkmcnt(15)
    v_mfma_f32_32x32x16_bf16 v[52:67], a[0:3], v[168:171], v[52:67]
    s_lshl_b32 s78, s100, 10
    s_add_u32 s78, s78, s24
    s_add_u32 s78, s78, 4096
    buffer_load_dwordx4 v[160:163], v17, s[52:55], s78 offen sc1
    ds_read_b64_tr_b16 a[42:43], v226 offset:25088
    ds_read_b64_tr_b16 a[44:45], v226 offset:24832
    v_mfma_f32_32x32x16_bf16 v[68:83], a[4:7], v[168:171], v[68:83]
    ds_read_b64_tr_b16 a[46:47], v226 offset:25344
    ds_read_b64_tr_b16 a[48:49], v226 offset:32768
    s_waitcnt vmcnt(14)
    v_mfma_f32_32x32x16_bf16 v[52:67], a[8:11], v[172:175], v[52:67]
    s_waitcnt lgkmcnt(15)
    s_lshl_b32 s78, s21, 10
    s_add_u32 s78, s78, s24
    buffer_load_dwordx4 v[164:167], v17, s[52:55], s78 offen sc1
    ds_read_b64_tr_b16 a[50:51], v226 offset:33280
    ds_read_b64_tr_b16 a[52:53], v226 offset:33024
    v_mfma_f32_32x32x16_bf16 v[68:83], a[12:15], v[172:175], v[68:83]
    ds_read_b64_tr_b16 a[54:55], v226 offset:33536
    ds_read_b64_tr_b16 a[56:57], v226 offset:0
    s_waitcnt vmcnt(14)
    v_mfma_f32_32x32x16_bf16 v[52:67], a[16:19], v[176:179], v[52:67]
    s_waitcnt lgkmcnt(15)
    ds_read_b64_tr_b16 a[58:59], v226 offset:512
    ds_read_b64_tr_b16 a[60:61], v226 offset:256
    v_mfma_f32_32x32x16_bf16 v[68:83], a[20:23], v[176:179], v[68:83]
    ds_read_b64_tr_b16 a[62:63], v226 offset:768
    ds_read_b64_tr_b16 a[64:65], v229 offset:0
    s_waitcnt vmcnt(13)
    v_mfma_f32_32x32x16_bf16 v[52:67], a[24:27], v[180:183], v[52:67]
    s_waitcnt lgkmcnt(15)
    s_add_u32 m0, s60, 14336
    s_lshl_b32 s77, s21, 14
    s_add_u32 s77, s77, s90
    buffer_load_dwordx4 v21, s[44:47], s77 offen lds
    buffer_load_dwordx4 v228, s[44:47], s77 offen offset:1024 lds
    ds_read_b64_tr_b16 a[66:67], v229 offset:512
    v_mfma_f32_32x32x16_bf16 v[68:83], a[28:31], v[180:183], v[68:83]
    ds_read_b64_tr_b16 a[68:69], v229 offset:256
    ds_read_b64_tr_b16 a[70:71], v229 offset:768
    buffer_load_dword v237, v231, s[52:55], s11 offen offset:512 sc1
    s_waitcnt vmcnt(15)
    v_mfma_f32_32x32x16_bf16 v[52:67], a[32:35], v[184:187], v[52:67]
    s_waitcnt lgkmcnt(15)
    ds_read_b64_tr_b16 a[72:73], v229 offset:2048
    ds_read_b64_tr_b16 a[74:75], v229 offset:2560
    v_mfma_f32_32x32x16_bf16 v[68:83], a[36:39], v[184:187], v[68:83]
    ds_read_b64_tr_b16 a[76:77], v229 offset:2304
    ds_read_b64_tr_b16 a[78:79], v229 offset:2816
    s_waitcnt vmcnt(14) lgkmcnt(15)
    v_mfma_f32_32x32x16_bf16 v[52:67], a[40:43], v[188:191], v[52:67]
    ds_read_b64_tr_b16 a[80:81], v229 offset:4096
    ds_read_b64_tr_b16 a[82:83], v229 offset:4608
    v_mfma_f32_32x32x16_bf16 v[68:83], a[44:47], v[188:191], v[68:83]
    ds_read_b64_tr_b16 a[84:85], v229 offset:4352
    ds_read_b64_tr_b16 a[86:87], v229 offset:4864
    s_waitcnt vmcnt(13) lgkmcnt(15)
    v_mfma_f32_32x32x16_bf16 v[52:67], a[48:51], v[192:195], v[52:67]
    ds_read_b64_tr_b16 a[88:89], v229 offset:6144
    ds_read_b64_tr_b16 a[90:91], v229 offset:6656
    v_mfma_f32_32x32x16_bf16 v[68:83], a[52:55], v[192:195], v[68:83]
    ds_read_b64_tr_b16 a[92:93], v229 offset:6400
    ds_read_b64_tr_b16 a[94:95], v229 offset:6912
    s_waitcnt vmcnt(12) lgkmcnt(15)
    v_mfma_f32_32x32x16_bf16 v[52:67], a[56:59], v[196:199], v[52:67]
    ds_read_b64_tr_b16 a[96:97], v229 offset:8192
    ds_read_b64_tr_b16 a[98:99], v229 offset:8704
    v_mfma_f32_32x32x16_bf16 v[68:83], a[60:63], v[196:199], v[68:83]
    ds_read_b64_tr_b16 a[100:101], v229 offset:8448
    ds_read_b64_tr_b16 a[102:103], v229 offset:8960
    s_waitcnt vmcnt(10) lgkmcnt(15)
    v_mfma_f32_32x32x16_bf16 v[52:67], a[64:67], v[200:203], v[52:67]
    ds_read_b64_tr_b16 a[104:105], v229 offset:10240
    ds_read_b64_tr_b16 a[106:107], v229 offset:10752
    v_mfma_f32_32x32x16_bf16 v[68:83], a[68:71], v[200:203], v[68:83]
    ds_read_b64_tr_b16 a[108:109], v229 offset:10496
    ds_read_b64_tr_b16 a[110:111], v229 offset:11008
    s_waitcnt vmcnt(9) lgkmcnt(15)
    v_mfma_f32_32x32x16_bf16 v[52:67], a[72:75], v[204:207], v[52:67]
    ds_read_b64_tr_b16 a[112:113], v229 offset:12288
    ds_read_b64_tr_b16 a[114:115], v229 offset:12800
    v_mfma_f32_32x32x16_bf16 v[68:83], a[76:79], v[204:207], v[68:83]
    ds_read_b64_tr_b16 a[116:117], v229 offset:12544
    ds_read_b64_tr_b16 a[118:119], v229 offset:13056
    s_waitcnt vmcnt(8) lgkmcnt(15)
    v_mfma_f32_32x32x16_bf16 v[52:67], a[80:83], v[208:211], v[52:67]
    v_mfma_f32_32x32x16_bf16 v[68:83], a[84:87], v[208:211], v[68:83]
    s_waitcnt vmcnt(7) lgkmcnt(14)
    v_mfma_f32_32x32x16_bf16 v[52:67], a[88:91], v[148:151], v[52:67]
    s_waitcnt lgkmcnt(12)
    v_mfma_f32_32x32x16_bf16 v[68:83], a[92:95], v[148:151], v[68:83]
    s_waitcnt vmcnt(6) lgkmcnt(10)
    v_mfma_f32_32x32x16_bf16 v[52:67], a[96:99], v[152:155], v[52:67]
    s_waitcnt lgkmcnt(8)
    v_mfma_f32_32x32x16_bf16 v[68:83], a[100:103], v[152:155], v[68:83]
    s_waitcnt vmcnt(5) lgkmcnt(6)
    v_mfma_f32_32x32x16_bf16 v[52:67], a[104:107], v[156:159], v[52:67]
    s_waitcnt lgkmcnt(4)
    v_mfma_f32_32x32x16_bf16 v[68:83], a[108:111], v[156:159], v[68:83]
    s_waitcnt vmcnt(4) lgkmcnt(2)
    v_mfma_f32_32x32x16_bf16 v[52:67], a[112:115], v[160:163], v[52:67]
    s_waitcnt lgkmcnt(0)
    v_mfma_f32_32x32x16_bf16 v[68:83], a[116:119], v[160:163], v[68:83]
    s_waitcnt vmcnt(1)
    ds_read_b64_tr_b16 a[120:121], v229 offset:14336
    ds_read_b64_tr_b16 a[122:123], v229 offset:14848
    ds_read_b64_tr_b16 a[124:125], v229 offset:14592
    ds_read_b64_tr_b16 a[126:127], v229 offset:15104
    s_waitcnt lgkmcnt(2)
    v_mfma_f32_32x32x16_bf16 v[52:67], a[120:123], v[164:167], v[52:67]
    s_waitcnt lgkmcnt(0)
    v_mfma_f32_32x32x16_bf16 v[68:83], a[124:127], v[164:167], v[68:83]
    s_waitcnt vmcnt(0)
    v_cmp_ne_u32 vcc, 1, v237
    s_nop 0
    s_cbranch_vccz L_cf26_x
L_cf26:
    buffer_load_dword v237, v231, s[52:55], s11 offen offset:512 sc1
    s_waitcnt vmcnt(0)
    v_cmp_ne_u32 vcc, 1, v237
    s_nop 0
    s_cbranch_vccz L_cf26_x
    s_add_u32 s79, s79, 1
    s_cmp_lt_u32 s79, 0x200000
    s_cbranch_scc1 L_cf26
L_cf26_x:
    s_lshl_b32 s78, s1, 10
    s_add_u32 s78, s78, s24
    s_add_u32 s78, s78, 88064
    buffer_load_dwordx4 v[168:171], v17, s[52:55], s78 offen sc1
    s_lshl_b32 s78, s1, 10
    s_add_u32 s78, s78, s24
    s_add_u32 s78, s78, 92160
    buffer_load_dwordx4 v[172:175], v17, s[52:55], s78 offen sc1
    s_lshl_b32 s78, s62, 10
    s_add_u32 s78, s78, s24
    s_add_u32 s78, s78, 88064
    buffer_load_dwordx4 v[176:179], v17, s[52:55], s78 offen sc1
    s_lshl_b32 s78, s13, 10
    s_add_u32 s78, s78, s24
    s_add_u32 s78, s78, 88064
    buffer_load_dwordx4 v[180:183], v17, s[52:55], s78 offen sc1
    s_lshl_b32 s78, s13, 10
    s_add_u32 s78, s78, s24
    s_add_u32 s78, s78, 92160
    buffer_load_dwordx4 v[184:187], v17, s[52:55], s78 offen sc1
    s_lshl_b32 s78, s63, 10
    s_add_u32 s78, s78, s24
    s_add_u32 s78, s78, 88064
    buffer_load_dwordx4 v[188:191], v17, s[52:55], s78 offen sc1
    s_lshl_b32 s78, s25, 10
    s_add_u32 s78, s78, s24
    s_add_u32 s78, s78, 88064
    buffer_load_dwordx4 v[192:195], v17, s[52:55], s78 offen sc1
    s_lshl_b32 s78, s25, 10
    s_add_u32 s78, s78, s24
    s_add_u32 s78, s78, 92160
    buffer_load_dwordx4 v[196:199], v17, s[52:55], s78 offen sc1
    s_lshl_b32 s78, s68, 10
    s_add_u32 s78, s78, s24
    s_add_u32 s78, s78, 88064
    buffer_load_dwordx4 v[200:203], v17, s[52:55], s78 offen sc1
    s_lshl_b32 s78, s56, 10
    s_add_u32 s78, s78, s24
    s_add_u32 s78, s78, 88064
    buffer_load_dwordx4 v[204:207], v17, s[52:55], s78 offen sc1
    s_lshl_b32 s78, s56, 10
    s_add_u32 s78, s78, s24
    s_add_u32 s78, s78, 92160
    buffer_load_dwordx4 v[208:211], v17, s[52:55], s78 offen sc1
    v_mfma_f32_32x32x16_bf16 v[84:99], a[192:195], v[212:215], 0
    v_mfma_f32_32x32x16_bf16 v[100:115], a[196:199], v[212:215], 0
    v_mfma_f32_32x32x16_bf16 v[84:99], a[200:203], v[216:219], v[84:99]
    s_lshl_b32 s78, s18, 10
    ds_write_b128 v240, v[52:55] offset:0
    s_add_u32 s78, s78, s24
    s_add_u32 s78, s78, 88064
    buffer_load_dwordx4 v[148:151], v17, s[52:55], s78 offen sc1
    v_mfma_f32_32x32x16_bf16 v[100:115], a[204:207], v[216:219], v[100:115]
    v_mfma_f32_32x32x16_bf16 v[84:99], a[208:211], v[220:223], v[84:99]
    s_lshl_b32 s78, s57, 10
    ds_write_b128 v241, v[56:59] offset:0
    s_add_u32 s78, s78, s24
    s_add_u32 s78, s78, 88064
    buffer_load_dwordx4 v[152:155], v17, s[52:55], s78 offen sc1
    v_mfma_f32_32x32x16_bf16 v[100:115], a[212:215], v[220:223], v[100:115]
    s_waitcnt vmcnt(12)
    v_mfma_f32_32x32x16_bf16 v[84:99], a[216:219], v[168:171], v[84:99]
    s_lshl_b32 s78, s57, 10
    ds_write_b128 v242, v[60:63] offset:0
    s_add_u32 s78, s78, s24
    s_add_u32 s78, s78, 92160
    buffer_load_dwordx4 v[156:159], v17, s[52:55], s78 offen sc1
    v_mfma_f32_32x32x16_bf16 v[100:115], a[220:223], v[168:171], v[100:115]
    s_waitcnt vmcnt(12)
    v_mfma_f32_32x32x16_bf16 v[84:99], a[224:227], v[172:175], v[84:99]
    s_lshl_b32 s78, s19, 10
    ds_write_b128 v243, v[64:67] offset:0
    s_add_u32 s78, s78, s24
    s_add_u32 s78, s78, 88064
    buffer_load_dwordx4 v[160:163], v17, s[52:55], s78 offen sc1
    v_mfma_f32_32x32x16_bf16 v[100:115], a[228:231], v[172:175], v[100:115]
    s_waitcnt vmcnt(12)
    v_mfma_f32_32x32x16_bf16 v[84:99], a[232:235], v[176:179], v[84:99]
    s_lshl_b32 s78, s58, 10
    ds_write_b128 v240, v[68:71] offset:128
    s_add_u32 s78, s78, s24
    s_add_u32 s78, s78, 88064
    buffer_load_dwordx4 v[164:167], v17, s[52:55], s78 offen sc1
    v_mfma_f32_32x32x16_bf16 v[100:115], a[236:239], v[176:179], v[100:115]
    s_waitcnt vmcnt(12)
    v_mfma_f32_32x32x16_bf16 v[84:99], a[240:243], v[180:183], v[84:99]
    s_lshl_b32 s78, s58, 10
    ds_write_b128 v241, v[72:75] offset:128
    s_add_u32 s78, s78, s24
    s_add_u32 s78, s78, 92160
    buffer_load_dwordx4 v[168:171], v17, s[52:55], s78 offen sc1
    v_mfma_f32_32x32x16_bf16 v[100:115], a[244:247], v[180:183], v[100:115]
    s_waitcnt vmcnt(12)
    v_mfma_f32_32x32x16_bf16 v[84:99], a[248:251], v[184:187], v[84:99]
    s_lshl_b32 s78, s20, 10
    ds_write_b128 v242, v[76:79] offset:128
    s_add_u32 s78, s78, s24
    s_add_u32 s78, s78, 88064
    buffer_load_dwordx4 v[172:175], v17, s[52:55], s78 offen sc1
    v_mfma_f32_32x32x16_bf16 v[100:115], a[252:255], v[184:187], v[100:115]
    s_waitcnt vmcnt(12)
    v_mfma_f32_32x32x16_bf16 v[84:99], a[0:3], v[188:191], v[84:99]
    s_lshl_b32 s78, s100, 10
    ds_write_b128 v243, v[80:83] offset:128
    s_add_u32 s78, s78, s24
    s_add_u32 s78, s78, 88064
    buffer_load_dwordx4 v[176:179], v17, s[52:55], s78 offen sc1
    v_mfma_f32_32x32x16_bf16 v[100:115], a[4:7], v[188:191], v[100:115]
    s_waitcnt vmcnt(12)
    v_mfma_f32_32x32x16_bf16 v[84:99], a[8:11], v[192:195], v[84:99]
    s_lshl_b32 s78, s100, 10
    s_add_u32 s78, s78, s24
    s_add_u32 s78, s78, 92160
    buffer_load_dwordx4 v[180:183], v17, s[52:55], s78 offen sc1
    v_mfma_f32_32x32x16_bf16 v[100:115], a[12:15], v[192:195], v[100:115]
    s_waitcnt vmcnt(12)
    v_mfma_f32_32x32x16_bf16 v[84:99], a[16:19], v[196:199], v[84:99]
    s_lshl_b32 s78, s21, 10
    s_add_u32 s78, s78, s24
    s_add_u32 s78, s78, 88064
    buffer_load_dwordx4 v[184:187], v17, s[52:55], s78 offen sc1
    v_mfma_f32_32x32x16_bf16 v[100:115], a[20:23], v[196:199], v[100:115]
    s_waitcnt lgkmcnt(0)
    s_barrier
    s_waitcnt vmcnt(12)
    v_mfma_f32_32x32x16_bf16 v[84:99], a[24:27], v[200:203], v[84:99]
    ds_read_b128 v[52:55], v244 offset:0
    v_mfma_f32_32x32x16_bf16 v[100:115], a[28:31], v[200:203], v[100:115]
    ds_read_b128 v[56:59], v245 offset:0
    s_waitcnt vmcnt(11)
    v_mfma_f32_32x32x16_bf16 v[84:99], a[32:35], v[204:207], v[84:99]
    ds_read_b128 v[60:63], v244 offset:16384
    v_mfma_f32_32x32x16_bf16 v[100:115], a[36:39], v[204:207], v[100:115]
    ds_read_b128 v[64:67], v245 offset:16384
    s_waitcnt vmcnt(10)
    v_mfma_f32_32x32x16_bf16 v[84:99], a[40:43], v[208:211], v[84:99]
    ds_read_b128 v[68:71], v246 offset:0
    v_mfma_f32_32x32x16_bf16 v[100:115], a[44:47], v[208:211], v[100:115]
    ds_read_b128 v[72:75], v247 offset:0
    s_waitcnt vmcnt(9)
    v_mfma_f32_32x32x16_bf16 v[84:99], a[48:51], v[148:151], v[84:99]
    ds_read_b128 v[76:79], v246 offset:16384
    v_mfma_f32_32x32x16_bf16 v[100:115], a[52:55], v[148:151], v[100:115]
    ds_read_b128 v[80:83], v247 offset:16384
    s_waitcnt vmcnt(8)
    v_mfma_f32_32x32x16_bf16 v[84:99], a[56:59], v[152:155], v[84:99]
    s_waitcnt lgkmcnt(7)
    v_add_f32 v40, v40, v52
    v_add_f32 v41, v41, v53
    v_add_f32 v42, v42, v54
    v_add_f32 v43, v43, v55
    s_waitcnt lgkmcnt(6)
    v_add_f32 v44, v44, v56
    v_add_f32 v45, v45, v57
    v_mfma_f32_32x32x16_bf16 v[100:115], a[60:63], v[152:155], v[100:115]
    v_add_f32 v46, v46, v58
    v_add_f32 v47, v47, v59
    s_waitcnt lgkmcnt(5)
    v_add_f32 v40, v40, v60
    v_add_f32 v41, v41, v61
    v_add_f32 v42, v42, v62
    v_add_f32 v43, v43, v63
    s_waitcnt vmcnt(7)
    v_mfma_f32_32x32x16_bf16 v[84:99], a[64:67], v[156:159], v[84:99]
    s_waitcnt lgkmcnt(4)
    v_add_f32 v44, v44, v64
    v_add_f32 v45, v45, v65
    v_add_f32 v46, v46, v66
    v_add_f32 v47, v47, v67
    s_waitcnt lgkmcnt(3)
    v_add_f32 v40, v40, v68
    v_add_f32 v41, v41, v69
    v_mfma_f32_32x32x16_bf16 v[100:115], a[68:71], v[156:159], v[100:115]
    v_add_f32 v42, v42, v70
    v_add_f32 v43, v43, v71
    s_waitcnt lgkmcnt(2)
    v_add_f32 v44, v44, v72
    v_add_f32 v45, v45, v73
    v_add_f32 v46, v46, v74
    v_add_f32 v47, v47, v75
    s_waitcnt vmcnt(6)
    v_mfma_f32_32x32x16_bf16 v[84:99], a[72:75], v[160:163], v[84:99]
    s_waitcnt lgkmcnt(1)
    v_add_f32 v40, v40, v76
    v_add_f32 v41, v41, v77
    v_add_f32 v42, v42, v78
    v_add_f32 v43, v43, v79
    s_waitcnt lgkmcnt(0)
    v_add_f32 v44, v44, v80
    v_add_f32 v45, v45, v81
    v_mfma_f32_32x32x16_bf16 v[100:115], a[76:79], v[160:163], v[100:115]
    v_add_f32 v46, v46, v82
    v_add_f32 v47, v47, v83
    v_cvt_pk_bf16_f32 v52, v40, v41
    v_cvt_pk_bf16_f32 v53, v42, v43
    v_cvt_pk_bf16_f32 v54, v44, v45
    v_cvt_pk_bf16_f32 v55, v46, v47
    s_waitcnt vmcnt(5)
    v_mfma_f32_32x32x16_bf16 v[84:99], a[80:83], v[164:167], v[84:99]
    buffer_store_dwordx4 v[52:55], v248, s[48:51], 0 offen sc1
    v_mfma_f32_32x32x16_bf16 v[100:115], a[84:87], v[164:167], v[100:115]
    s_waitcnt vmcnt(5)
    v_mfma_f32_32x32x16_bf16 v[84:99], a[88:91], v[168:171], v[84:99]
    v_mfma_f32_32x32x16_bf16 v[100:115], a[92:95], v[168:171], v[100:115]
    s_waitcnt vmcnt(4)
    v_mfma_f32_32x32x16_bf16 v[84:99], a[96:99], v[172:175], v[84:99]
    v_mfma_f32_32x32x16_bf16 v[100:115], a[100:103], v[172:175], v[100:115]
    s_waitcnt vmcnt(3)
    v_mfma_f32_32x32x16_bf16 v[84:99], a[104:107], v[176:179], v[84:99]
    v_mfma_f32_32x32x16_bf16 v[100:115], a[108:111], v[176:179], v[100:115]
    s_waitcnt vmcnt(2)
    v_mfma_f32_32x32x16_bf16 v[84:99], a[112:115], v[180:183], v[84:99]
    v_mfma_f32_32x32x16_bf16 v[100:115], a[116:119], v[180:183], v[100:115]
    s_waitcnt vmcnt(1)
    v_mfma_f32_32x32x16_bf16 v[84:99], a[120:123], v[184:187], v[84:99]
    v_mfma_f32_32x32x16_bf16 v[100:115], a[124:127], v[184:187], v[100:115]
    s_nop 10
    ds_write_b128 v240, v[84:87] offset:8192
    ds_write_b128 v241, v[88:91] offset:8192
    ds_write_b128 v242, v[92:95] offset:8192
    ds_write_b128 v243, v[96:99] offset:8192
    ds_write_b128 v240, v[100:103] offset:8320
    ds_write_b128 v241, v[104:107] offset:8320
    ds_write_b128 v242, v[108:111] offset:8320
    ds_write_b128 v243, v[112:115] offset:8320
    s_waitcnt lgkmcnt(0)
    s_barrier
    ds_read_b128 v[148:151], v244 offset:8192
    ds_read_b128 v[152:155], v245 offset:8192
    ds_read_b128 v[156:159], v244 offset:24576
    ds_read_b128 v[160:163], v245 offset:24576
    ds_read_b128 v[164:167], v246 offset:8192
    ds_read_b128 v[168:171], v247 offset:8192
    ds_read_b128 v[172:175], v246 offset:24576
    ds_read_b128 v[176:179], v247 offset:24576
    s_waitcnt lgkmcnt(7)
    v_pk_add_f32 v[116:117], v[116:117], v[148:149]
    v_pk_add_f32 v[118:119], v[118:119], v[150:151]
    s_waitcnt lgkmcnt(6)
    v_pk_add_f32 v[120:121], v[120:121], v[152:153]
    v_pk_add_f32 v[122:123], v[122:123], v[154:155]
    s_waitcnt lgkmcnt(5)
    v_pk_add_f32 v[116:117], v[116:117], v[156:157]
    v_pk_add_f32 v[118:119], v[118:119], v[158:159]
    s_waitcnt lgkmcnt(4)
    v_pk_add_f32 v[120:121], v[120:121], v[160:161]
    v_pk_add_f32 v[122:123], v[122:123], v[162:163]
    s_waitcnt lgkmcnt(3)
    v_pk_add_f32 v[116:117], v[116:117], v[164:165]
    v_pk_add_f32 v[118:119], v[118:119], v[166:167]
    s_waitcnt lgkmcnt(2)
    v_pk_add_f32 v[120:121], v[120:121], v[168:169]
    v_pk_add_f32 v[122:123], v[122:123], v[170:171]
    s_waitcnt lgkmcnt(1)
    v_pk_add_f32 v[116:117], v[116:117], v[172:173]
    v_pk_add_f32 v[118:119], v[118:119], v[174:175]
    s_waitcnt lgkmcnt(0)
    v_pk_add_f32 v[120:121], v[120:121], v[176:177]
    v_pk_add_f32 v[122:123], v[122:123], v[178:179]
    v_cvt_pk_bf16_f32 v148, v116, v117
    v_cvt_pk_bf16_f32 v149, v118, v119
    v_cvt_pk_bf16_f32 v150, v120, v121
    v_cvt_pk_bf16_f32 v151, v122, v123
    buffer_store_dwordx4 v[148:151], v249, s[48:51], 0 offen sc1
T7:
    s_cbranch_execz L_tret
L_end:
    s_endpgm
L_code_end:
.section .rodata,"a"
.p2align 6
.amdhsa_kernel sequential_preLN__linear_attn_block__mixer_channel_mlp__prompt_kernel
  .amdhsa_next_free_vgpr 512
  .amdhsa_next_free_sgpr 102
  .amdhsa_accum_offset 256
  .amdhsa_group_segment_fixed_size 0
  .amdhsa_kernarg_size 88
  .amdhsa_user_sgpr_count 2
  .amdhsa_user_sgpr_kernarg_segment_ptr 1
  .amdhsa_system_sgpr_workgroup_id_x 1
.end_amdhsa_kernel
```
